```python
import torch

def _softmax(x, axis=-1):
    return torch.softmax(x, dim=axis)
def _gelu(x):
    return torch.nn.functional.gelu(x, approximate="tanh")
def _silu(x):
    return torch.nn.functional.silu(x)
def _sigmoid(x):
    return torch.sigmoid(x)
def _layernorm(x, axis=-1, eps=1e-5):
    m = x.mean(dim=axis, keepdim=True)
    v = x.var(dim=axis, keepdim=True, unbiased=False)
    return (x - m) / torch.sqrt(v + eps)
def _scatter_add(tgt, idx, src, axis=0):
    return tgt.clone().index_add_(axis, idx, src)
def _segment_sum(src, seg, n):
    out = torch.zeros((n,) + src.shape[1:], dtype=src.dtype)
    return out.index_add_(0, seg, src)
def _pad(x, pw):
    flat = tuple(v for pair in reversed(pw) for v in pair)
    return torch.nn.functional.pad(x, flat)

kernel_name = 'recurrent_scan__sliding_block_cached__swiglu_ffn__decode'

def setup_inputs():

    _w = (lambda a: (lambda t: t.to(torch.bfloat16) if t.is_floating_point() else t)(torch.as_tensor(a)))
    def _A_setup():
        B, Sq, D = 8, 1, 512
        Hq, Hkv, Sk, Dh = 32, 8, 4096, 128
        assert Hq % Hkv == 0, (Hq, Hkv)
        return {
            "x": _w((lambda *s: torch.randn(*s, dtype=torch.bfloat16) * 0.05)(B, Sq, D)),
            "k_cache": _w((lambda *s: torch.randn(*s, dtype=torch.bfloat16) * 0.8)(B, Hkv, Sk, Dh)),
            "v_cache": _w((lambda *s: torch.randn(*s, dtype=torch.bfloat16) * 0.2)(B, Hkv, Sk, Dh)),
            "wq": _w((lambda *s: torch.randn(*s, dtype=torch.bfloat16) * 0.8)(D, Hq * Dh) * (D ** -0.5)),
            "wo": _w((lambda *s: torch.randn(*s, dtype=torch.bfloat16) * 0.2)(Hq * Dh, D) * ((Hq * Dh) ** -0.5)),
        }
    _A_in = _A_setup()

    def _B_setup():
        B, S, D, F = 8, 1, 512, 1792
        return {
            "x": _w((lambda *s: torch.randn(*s, dtype=torch.bfloat16) * 0.05)(B, S, D)),
            "w_gate": _w((lambda *s: torch.randn(*s, dtype=torch.bfloat16) * 0.1)(D, F)),
            "w_up": _w((lambda *s: torch.randn(*s, dtype=torch.bfloat16) * 0.1)(D, F)),
            "w_down": _w((lambda *s: torch.randn(*s, dtype=torch.bfloat16) * 0.1)(F, D)),
        }
    _B_in = _B_setup()

    return {
        "A_x": _A_in["x"],
        "A_k_cache": _A_in["k_cache"],
        "A_v_cache": _A_in["v_cache"],
        "A_wq": _A_in["wq"],
        "A_wo": _A_in["wo"],
        "B_x": _B_in["x"],
        "B_w_gate": _B_in["w_gate"],
        "B_w_up": _B_in["w_up"],
        "B_w_down": _B_in["w_down"],
    }

def reference(A_x, A_k_cache, A_v_cache, A_wq, A_wo, B_x, B_w_gate, B_w_up, B_w_down):
    def _A_ref(x, k_cache, v_cache, wq, wo):
        B, Sq, D = x.shape
        Hq, Dh = 32, 128
        Hkv, Sk = k_cache.shape[1], k_cache.shape[2]
        W = min(4096, max(256, Sk // 4))
        rep = Hq // Hkv
        q = (lambda x, *d: x.permute(*d))((x @ wq).reshape(B, Sq, Hq, Dh), 0, 2, 1, 3)
        k = (lambda x, n, axis: torch.repeat_interleave(x, n, dim=axis))(k_cache[:, :, Sk - W:, :], rep, axis=1)
        v = (lambda x, n, axis: torch.repeat_interleave(x, n, dim=axis))(v_cache[:, :, Sk - W:, :], rep, axis=1)
        scores = torch.einsum("bhqd,bhkd->bhqk", q, k) * (Dh ** -0.5)
        p = _softmax(scores, axis=-1)
        o = torch.einsum("bhqk,bhkd->bhqd", p, v)
        return (lambda x, *d: x.permute(*d))(o, 0, 2, 1, 3).reshape(B, Sq, Hq * Dh) @ wo

    def _B_ref(x, w_gate, w_up, w_down):
        g = _silu(x @ w_gate)
        u = x @ w_up
        return (g * u) @ w_down

    x = A_x
    xn = _layernorm(x, axis=-1)
    s = _A_ref(xn, A_k_cache, A_v_cache, A_wq, A_wo)
    g = _silu(_B_ref(xn, B_w_gate, B_w_up, B_w_down))
    return x + s * g
```

```asm
; @launch grid=(256,1,1) block=(576,1,1) lds=161792
.amdgcn_target "amdgcn-amd-amdhsa--gfx950"
.text
.globl recurrent_scan__sliding_block_cached__swiglu_ffn__decode_kernel
.p2align 8
.type recurrent_scan__sliding_block_cached__swiglu_ffn__decode_kernel,@function
recurrent_scan__sliding_block_cached__swiglu_ffn__decode_kernel:
  s_cmp_ge_u32 s2, 256
  s_cbranch_scc1 L_end
  s_load_dwordx16 s[4:19], s[0:1], 0
  s_load_dwordx8 s[20:27], s[0:1], 64
  v_lshrrev_b32 v1, 6, v0
  v_and_b32 v2, 63, v0
  v_readfirstlane_b32 s3, v1
  v_mov_b32 v3, 0
  v_mov_b32 v4, 1
  v_and_b32 v5, 15, v2
  v_lshrrev_b32 v6, 4, v2
  s_mov_b32 s30, 67108864
  s_mov_b32 s31, 0x00020000
  s_mov_b32 s34, 67108864
  s_mov_b32 s35, 0x00020000
  s_mov_b32 s46, 4194304
  s_mov_b32 s47, 0x00020000
  s_mov_b32 s50, 1835008
  s_mov_b32 s51, 0x00020000
  s_mov_b32 s54, 268435456
  s_mov_b32 s55, 0x00020000
  s_mov_b32 s58, 8192
  s_mov_b32 s59, 0x00020000
  s_mov_b32 s62, 8192
  s_mov_b32 s63, 0x00020000
  s_mov_b32 s39, 0x00020000
  s_and_b32 s70, s2, 7
  s_lshr_b32 s71, s2, 3
  s_lshr_b32 s72, s71, 2
  s_and_b32 s73, s71, 3
  s_lshl_b32 s74, s70, 2
  s_lshr_b32 s68, s71, 3
  s_add_u32 s74, s74, s68
  s_and_b32 s75, s71, 7
  s_lshl_b32 s64, s72, 3
  s_add_u32 s64, s64, s70
  s_lshl_b32 s64, s64, 20
  s_lshl_b32 s68, s73, 16
  s_add_u32 s64, s64, s68
  s_add_u32 s64, s64, 786432
  s_cmp_ge_u32 s3, 4
  s_cbranch_scc1 L_H
  s_lshl_b32 s68, s3, 14
  s_add_u32 s76, s64, s68
  v_xor_b32 v7, v5, v6
  v_lshlrev_b32 v7, 4, v7
  v_lshl_add_u32 v128, v6, 8, v7
  v_xor_b32 v129, 64, v128
  v_xor_b32 v130, 128, v128
  v_xor_b32 v131, 192, v128
  v_lshl_add_u32 v132, v5, 8, v7
  s_lshl_b32 s68, s3, 13
  v_add_u32 v132, s68, v132
  v_xor_b32 v133, 64, v132
  v_xor_b32 v134, 128, v132
  v_xor_b32 v135, 192, v132
  v_add_u32 v136, 0x1f800, v132
  v_add_u32 v137, 0x1f800, v133
  v_add_u32 v138, 0x1f800, v134
  v_add_u32 v139, 0x1f800, v135
  s_add_u32 s77, s68, 129024
  s_add_u32 s78, s68, 30720
  s_waitcnt lgkmcnt(0)
  s_mov_b32 s28, s6
  s_mov_b32 s29, s7
  s_mov_b32 s52, s26
  s_mov_b32 s53, s27
  s_barrier
  s_mov_b32 m0, s77
  s_add_u32 s77, s77, 1024
  buffer_load_dwordx4 v128, s[28:31], s76 offen nt lds
  s_add_u32 s76, s76, 1024
  s_mov_b32 m0, s77
  s_add_u32 s77, s77, 1024
  buffer_load_dwordx4 v129, s[28:31], s76 offen nt lds
  s_add_u32 s76, s76, 1024
  s_mov_b32 m0, s77
  s_add_u32 s77, s77, 1024
  buffer_load_dwordx4 v130, s[28:31], s76 offen nt lds
  s_add_u32 s76, s76, 1024
  s_mov_b32 m0, s77
  s_add_u32 s77, s77, 1024
  buffer_load_dwordx4 v131, s[28:31], s76 offen nt lds
  s_add_u32 s76, s76, 1024
  s_mov_b32 m0, s77
  s_add_u32 s77, s77, 1024
  buffer_load_dwordx4 v128, s[28:31], s76 offen nt lds
  s_add_u32 s76, s76, 1024
  s_waitcnt vmcnt(4)
  s_mov_b32 m0, s77
  s_add_u32 s77, s77, 1024
  buffer_load_dwordx4 v129, s[28:31], s76 offen nt lds
  s_add_u32 s76, s76, 1024
  s_waitcnt vmcnt(4)
  s_mov_b32 m0, s77
  s_add_u32 s77, s77, 1024
  buffer_load_dwordx4 v130, s[28:31], s76 offen nt lds
  s_add_u32 s76, s76, 1024
  s_waitcnt vmcnt(4)
  s_mov_b32 m0, s77
  s_add_u32 s77, s77, 1024
  buffer_load_dwordx4 v131, s[28:31], s76 offen nt lds
  s_add_u32 s76, s76, 1024
  s_mov_b32 s15, 0x400000
FW_1:
  ds_read_b32 v10, v3 offset:52
  s_waitcnt lgkmcnt(0)
  v_readfirstlane_b32 s14, v10
  s_cmp_ge_u32 s14, 2
  s_cbranch_scc1 FD_2
  s_sleep 1
  s_sub_u32 s15, s15, 1
  s_cmp_lg_u32 s15, 0
  s_cbranch_scc1 FW_1
FD_2:
  s_waitcnt vmcnt(4)
  s_mov_b32 m0, s78
  s_add_u32 s78, s78, 1024
  buffer_load_dwordx4 v128, s[28:31], s76 offen nt lds
  s_add_u32 s76, s76, 1024
  s_waitcnt vmcnt(4)
  s_mov_b32 m0, s78
  s_add_u32 s78, s78, 1024
  buffer_load_dwordx4 v129, s[28:31], s76 offen nt lds
  s_add_u32 s76, s76, 1024
  s_waitcnt lgkmcnt(0)
  s_mov_b64 exec, 1
  ds_add_u32 v3, v4 offset:20
  s_mov_b64 exec, -1
  s_waitcnt vmcnt(4)
  s_mov_b32 m0, s78
  s_add_u32 s78, s78, 1024
  buffer_load_dwordx4 v130, s[28:31], s76 offen nt lds
  s_add_u32 s76, s76, 1024
  s_waitcnt vmcnt(4)
  s_mov_b32 m0, s78
  s_add_u32 s78, s78, 1024
  buffer_load_dwordx4 v131, s[28:31], s76 offen nt lds
  s_add_u32 s76, s76, 1024
  s_waitcnt vmcnt(4)
  s_mov_b32 m0, s78
  s_add_u32 s78, s78, 1024
  buffer_load_dwordx4 v128, s[28:31], s76 offen nt lds
  s_add_u32 s76, s76, 1024
  s_waitcnt vmcnt(4)
  s_mov_b32 m0, s78
  s_add_u32 s78, s78, 1024
  buffer_load_dwordx4 v129, s[28:31], s76 offen nt lds
  s_add_u32 s76, s76, 1024
  s_waitcnt vmcnt(4)
  s_mov_b32 m0, s78
  s_add_u32 s78, s78, 1024
  buffer_load_dwordx4 v130, s[28:31], s76 offen nt lds
  s_add_u32 s76, s76, 1024
  s_waitcnt vmcnt(4)
  s_mov_b32 m0, s78
  s_add_u32 s78, s78, 1024
  buffer_load_dwordx4 v131, s[28:31], s76 offen nt lds
  s_add_u32 s76, s76, 1024
  s_waitcnt lgkmcnt(0)
  s_mov_b64 exec, 1
  ds_add_u32 v3, v4 offset:36
  s_mov_b64 exec, -1
  s_mov_b32 s78, 0x3e0293ee
  v_and_b32 v11, 3, v2
  v_lshlrev_b32 v12, 8, v11
  v_lshl_add_u32 v12, v6, 4, v12
  v_lshlrev_b32 v13, 4, v11
  s_lshl_b32 s68, s3, 2
  v_add_u32 v14, s68, v13
  v_mul_u32_u24 v8, 528, v11
  v_lshl_add_u32 v9, v6, 4, v8
  v_lshl_add_u32 v8, v6, 3, v8
  s_lshl_b32 s68, s3, 7
  v_add_u32 v8, s68, v8
  v_lshrrev_b32 v124, 2, v5
  v_and_b32 v125, 1, v6
  v_lshl_add_u32 v125, v125, 2, v124
  v_lshlrev_b32 v125, 1, v125
  v_lshrrev_b32 v126, 1, v11
  s_lshl_b32 s68, s3, 2
  v_add_u32 v126, s68, v126
  v_xor_b32 v126, v126, v125
  v_lshlrev_b32 v126, 4, v126
  v_and_b32 v125, 1, v2
  v_lshl_add_u32 v126, v125, 3, v126
  v_lshl_add_u32 v125, v6, 3, v124
  v_lshl_add_u32 v126, v125, 8, v126
  v_xor_b32 v127, 32, v126
  v_add_u32 v126, 63488, v126
  v_add_u32 v127, 63488, v127
  v_lshlrev_b32 v125, 6, v11
  v_lshl_add_u32 v125, v6, 4, v125
  s_lshl_b32 s79, s70, 2
  s_add_u32 s79, s79, s73
  s_lshl_b32 s79, s79, 3
  s_add_u32 s79, s79, s72
  s_lshl_b32 s79, s79, 2
  s_add_u32 s79, s79, s3
  s_lshl_b32 s79, s79, 8
  s_add_u32 s79, s79, 983040
  s_waitcnt vmcnt(12)
  ds_read_b128 v[16:19], v136 offset:0
  ds_read_b128 v[20:23], v137 offset:0
  ds_read_b128 v[24:27], v138 offset:0
  ds_read_b128 v[28:31], v139 offset:0
  s_waitcnt vmcnt(8)
  ds_read_b128 v[32:35], v136 offset:4096
  ds_read_b128 v[36:39], v137 offset:4096
  ds_read_b128 v[40:43], v138 offset:4096
  ds_read_b128 v[44:47], v139 offset:4096
  s_waitcnt vmcnt(4)
  ds_read_b128 v[48:51], v132 offset:30720
  ds_read_b128 v[52:55], v133 offset:30720
  ds_read_b128 v[56:59], v134 offset:30720
  ds_read_b128 v[60:63], v135 offset:30720
  s_waitcnt vmcnt(0)
  ds_read_b128 v[64:67], v132 offset:34816
  ds_read_b128 v[68:71], v133 offset:34816
  ds_read_b128 v[72:75], v134 offset:34816
  ds_read_b128 v[76:79], v135 offset:34816
  s_mov_b32 s15, 0x400000
FW_3:
  ds_read_b32 v10, v3 offset:4
  s_waitcnt lgkmcnt(0)
  v_readfirstlane_b32 s14, v10
  s_cmp_ge_u32 s14, 1
  s_cbranch_scc1 FD_4
  s_sleep 1
  s_sub_u32 s15, s15, 1
  s_cmp_lg_u32 s15, 0
  s_cbranch_scc1 FW_3
FD_4:
  ds_read_b128 v[80:83], v12 offset:2560
  ds_read_b128 v[84:87], v12 offset:2624
  ds_read_b128 v[88:91], v12 offset:2688
  ds_read_b128 v[92:95], v12 offset:2752
  s_waitcnt lgkmcnt(0)
  v_mfma_f32_16x16x32_bf16 v[96:99], v[16:19], v[80:83], 0
  v_mfma_f32_16x16x32_bf16 v[96:99], v[20:23], v[84:87], v[96:99]
  v_mfma_f32_16x16x32_bf16 v[96:99], v[24:27], v[88:91], v[96:99]
  v_mfma_f32_16x16x32_bf16 v[96:99], v[28:31], v[92:95], v[96:99]
  v_mfma_f32_16x16x32_bf16 v[100:103], v[32:35], v[80:83], 0
  v_mfma_f32_16x16x32_bf16 v[100:103], v[36:39], v[84:87], v[100:103]
  v_mfma_f32_16x16x32_bf16 v[100:103], v[40:43], v[88:91], v[100:103]
  v_mfma_f32_16x16x32_bf16 v[100:103], v[44:47], v[92:95], v[100:103]
  v_mfma_f32_16x16x32_bf16 v[104:107], v[48:51], v[80:83], 0
  v_mfma_f32_16x16x32_bf16 v[104:107], v[52:55], v[84:87], v[104:107]
  v_mfma_f32_16x16x32_bf16 v[104:107], v[56:59], v[88:91], v[104:107]
  v_mfma_f32_16x16x32_bf16 v[104:107], v[60:63], v[92:95], v[104:107]
  v_mfma_f32_16x16x32_bf16 v[108:111], v[64:67], v[80:83], 0
  v_mfma_f32_16x16x32_bf16 v[108:111], v[68:71], v[84:87], v[108:111]
  v_mfma_f32_16x16x32_bf16 v[108:111], v[72:75], v[88:91], v[108:111]
  v_mfma_f32_16x16x32_bf16 v[108:111], v[76:79], v[92:95], v[108:111]
  s_nop 3
  v_max3_f32 v10, v96, v97, v98
  v_max3_f32 v10, v10, v99, v100
  v_max3_f32 v10, v10, v101, v102
  v_max3_f32 v10, v10, v103, v104
  v_max3_f32 v10, v10, v105, v106
  v_max_f32 v10, v10, v107
  v_max3_f32 v10, v10, v108, v109
  v_max3_f32 v10, v10, v110, v111
  v_mov_b32 v15, v10
  s_nop 1
  v_permlane16_swap_b32 v10, v15
  s_nop 0
  v_max_f32 v10, v10, v15
  v_mov_b32 v15, v10
  s_nop 1
  v_permlane32_swap_b32 v10, v15
  s_nop 0
  v_max_f32 v10, v10, v15
  s_mov_b64 exec, 15
  ds_write_b32 v14, v10 offset:64
  s_waitcnt lgkmcnt(0)
  s_mov_b64 exec, 1
  ds_add_u32 v3, v4 offset:12
  s_mov_b64 exec, -1
  s_mov_b32 s15, 0x400000
FW_5:
  ds_read_b32 v15, v3 offset:12
  s_waitcnt lgkmcnt(0)
  v_readfirstlane_b32 s14, v15
  s_cmp_ge_u32 s14, 4
  s_cbranch_scc1 FD_6
  s_sub_u32 s15, s15, 1
  s_cmp_lg_u32 s15, 0
  s_cbranch_scc1 FW_5
FD_6:
  ds_read_b128 v[112:115], v13 offset:64
  s_waitcnt lgkmcnt(0)
  v_max3_f32 v10, v112, v113, v114
  v_max_f32 v10, v10, v115
  v_mul_f32 v10, s78, v10
  v_fma_f32 v96, v96, s78, -v10
  v_fma_f32 v97, v97, s78, -v10
  v_fma_f32 v98, v98, s78, -v10
  v_fma_f32 v99, v99, s78, -v10
  v_fma_f32 v100, v100, s78, -v10
  v_fma_f32 v101, v101, s78, -v10
  v_fma_f32 v102, v102, s78, -v10
  v_fma_f32 v103, v103, s78, -v10
  v_fma_f32 v104, v104, s78, -v10
  v_fma_f32 v105, v105, s78, -v10
  v_fma_f32 v106, v106, s78, -v10
  v_fma_f32 v107, v107, s78, -v10
  v_fma_f32 v108, v108, s78, -v10
  v_fma_f32 v109, v109, s78, -v10
  v_fma_f32 v110, v110, s78, -v10
  v_fma_f32 v111, v111, s78, -v10
  v_exp_f32 v96, v96
  v_exp_f32 v97, v97
  v_exp_f32 v98, v98
  v_exp_f32 v99, v99
  v_exp_f32 v100, v100
  v_exp_f32 v101, v101
  v_exp_f32 v102, v102
  v_exp_f32 v103, v103
  v_exp_f32 v104, v104
  v_exp_f32 v105, v105
  v_exp_f32 v106, v106
  v_exp_f32 v107, v107
  v_exp_f32 v108, v108
  v_exp_f32 v109, v109
  v_exp_f32 v110, v110
  v_exp_f32 v111, v111
  s_nop 0
  v_cvt_pk_bf16_f32 v112, v96, v97
  v_cvt_pk_bf16_f32 v113, v98, v99
  v_cvt_pk_bf16_f32 v114, v100, v101
  v_cvt_pk_bf16_f32 v115, v102, v103
  v_cvt_pk_bf16_f32 v116, v104, v105
  v_cvt_pk_bf16_f32 v117, v106, v107
  v_cvt_pk_bf16_f32 v118, v108, v109
  v_cvt_pk_bf16_f32 v119, v110, v111
  s_mov_b32 exec_lo, 0x000f000f
  s_mov_b32 exec_hi, 0x000f000f
  ds_write_b64 v8, v[112:113] offset:3584
  ds_write_b64 v8, v[114:115] offset:3616
  ds_write_b64 v8, v[116:117] offset:3648
  ds_write_b64 v8, v[118:119] offset:3680
  s_mov_b64 exec, -1
  v_add_f32 v10, v96, v97
  v_add_f32 v15, v98, v99
  v_add_f32 v10, v10, v100
  v_add_f32 v15, v15, v101
  v_add_f32 v10, v10, v102
  v_add_f32 v15, v15, v103
  v_add_f32 v10, v10, v104
  v_add_f32 v15, v15, v105
  v_add_f32 v10, v10, v106
  v_add_f32 v15, v15, v107
  v_add_f32 v10, v10, v108
  v_add_f32 v15, v15, v109
  v_add_f32 v10, v10, v110
  v_add_f32 v15, v15, v111
  v_add_f32 v10, v10, v15
  v_mov_b32 v15, v10
  s_nop 1
  v_permlane16_swap_b32 v10, v15
  s_nop 0
  v_add_f32 v10, v10, v15
  v_mov_b32 v15, v10
  s_nop 1
  v_permlane32_swap_b32 v10, v15
  s_nop 0
  v_add_f32 v10, v10, v15
  s_mov_b64 exec, 15
  ds_write_b32 v14, v10 offset:128
  s_waitcnt lgkmcnt(0)
  s_mov_b64 exec, 1
  ds_add_u32 v3, v4 offset:16
  s_mov_b64 exec, -1
  s_mov_b32 s15, 0x400000
FW_7:
  ds_read_b32 v15, v3 offset:16
  s_waitcnt lgkmcnt(0)
  v_readfirstlane_b32 s14, v15
  s_cmp_ge_u32 s14, 4
  s_cbranch_scc1 FD_8
  s_sub_u32 s15, s15, 1
  s_cmp_lg_u32 s15, 0
  s_cbranch_scc1 FW_7
FD_8:
  ds_read_b128 v[16:19], v9 offset:3584
  ds_read_b128 v[20:23], v9 offset:3648
  ds_read_b128 v[24:27], v9 offset:3712
  ds_read_b128 v[28:31], v9 offset:3776
  ds_read_b128 v[32:35], v9 offset:3840
  ds_read_b128 v[36:39], v9 offset:3904
  ds_read_b128 v[40:43], v9 offset:3968
  ds_read_b128 v[44:47], v9 offset:4032
  s_lshl_b32 s68, s3, 4
  v_mov_b32 v113, s68
  ds_read_b128 v[116:119], v113 offset:64
  ds_read_b128 v[120:123], v113 offset:128
  s_waitcnt lgkmcnt(0)
  v_max3_f32 v114, v116, v117, v118
  v_max_f32 v114, v114, v119
  v_mul_f32 v114, s78, v114
  v_add_f32 v115, v120, v121
  v_add_f32 v116, v122, v123
  v_add_f32 v115, v115, v116
  v_min_u32 v114, -2, v114
  v_min_u32 v115, -2, v115
  s_lshl_b32 s36, s70, 2
  s_add_u32 s36, s36, s3
  s_lshl_b32 s36, s36, 8
  s_lshl_b32 s68, s71, 3
  s_add_u32 s36, s36, s68
  s_add_u32 s36, s36, 4063232
  s_lshl_b32 s37, s70, 5
  s_add_u32 s37, s37, s71
  s_lshl_b32 s37, s37, 7
  s_lshl_b32 s68, s3, 3
  s_add_u32 s37, s37, s68
  s_add_u32 s37, s37, 1835008
  v_and_b32 v100, 7, v2
  v_lshl_add_u32 v101, v6, 2, v124
  v_bfe_u32 v109, v101, 1, 2
  v_lshlrev_b32 v101, 7, v101
  v_lshl_add_u32 v101, v109, 5, v101
  v_lshl_add_u32 v101, v11, 3, v101
  s_and_b32 s68, s3, 1
  s_lshl_b32 s69, s68, 13
  v_add_u32 v101, s69, v101
  v_xor_b32 v109, 32, v101
  v_xor_b32 v110, 64, v101
  v_xor_b32 v111, 0x60, v101
  v_lshlrev_b32 v102, 10, v5
  v_lshl_add_u32 v102, v6, 4, v102
  s_lshl_b32 s77, s70, 15
  s_lshr_b32 s69, s3, 1
  s_lshl_b32 s69, s69, 14
  s_add_u32 s77, s77, s69
  s_lshl_b32 s68, s68, 9
  s_add_u32 s77, s77, s68
  s_lshr_b32 s68, s71, 3
  s_lshl_b32 s68, s68, 6
  s_add_u32 s77, s77, s68
  s_add_u32 s77, s77, 983040
  v_bfe_u32 v103, v2, 3, 1
  s_lshl_b32 s68, s3, 1
  v_add_u32 v104, s68, v103
  v_mul_u32_u24 v104, 2176, v104
  v_mul_u32_u24 v105, 272, v100
  v_add_u32 v104, v104, v105
  v_lshl_add_u32 v104, v6, 4, v104
  s_and_b32 s69, s3, 2
  v_add_u32 v103, s69, v103
  v_lshl_add_u32 v103, v103, 4, v5
  v_lshlrev_b32 v103, 2, v103
  v_lshl_add_u32 v108, v100, 2, v6
  v_lshlrev_b32 v108, 7, v108
  s_lshl_b32 s65, s70, 12
  s_lshr_b32 s69, s71, 3
  s_lshl_b32 s69, s69, 3
  s_add_u32 s65, s65, s69
  s_add_u32 s65, s65, 1835008
  v_lshrrev_b32 v105, 5, v2
  v_add_u32 v106, s68, v105
  v_mul_u32_u24 v106, 272, v106
  v_and_b32 v107, 31, v2
  v_lshl_add_u32 v106, v107, 3, v106
  v_lshlrev_b32 v105, 10, v105
  v_lshl_add_u32 v105, v107, 2, v105
  s_lshl_b32 s78, s74, 3
  s_add_u32 s78, s78, s68
  s_lshl_b32 s78, s78, 10
  s_lshl_b32 s69, s75, 7
  s_add_u32 s78, s78, s69
  s_add_u32 s78, s78, 1253376
  s_add_u32 s66, s79, 2097152
  s_add_u32 s67, s77, 2097152
  s_lshl_b32 s40, s74, 8
  s_add_u32 s40, s40, 4063232
  v_lshrrev_b32 v112, 4, v108
  s_mov_b32 s76, 0
  s_waitcnt lgkmcnt(0)
  s_cmp_gt_u32 s76, 0
  s_cbranch_scc1 VR_10
  s_mov_b32 s15, 0x400000
VW_9:
  ds_read_b64 v[96:97], v3 offset:24
  s_waitcnt lgkmcnt(0)
  v_add_u32 v97, 7, v97
  v_min_u32 v96, v96, v97
  v_readfirstlane_b32 s41, v97
  s_sub_u32 s15, s15, 1
  v_readfirstlane_b32 s76, v96
  s_cmp_eq_u32 s15, 0
  s_cbranch_scc1 VR_10
  s_cmp_gt_u32 s76, 0
  s_cbranch_scc0 VW_9
VR_10:
  ds_read_b64_tr_b16 v[128:129], v126 offset:0
  ds_read_b64_tr_b16 v[130:131], v126 offset:1024
  ds_read_b64_tr_b16 v[132:133], v127 offset:0
  ds_read_b64_tr_b16 v[134:135], v127 offset:1024
  s_cmp_gt_u32 s76, 1
  s_cbranch_scc1 VR_12
  s_mov_b32 s15, 0x400000
VW_11:
  ds_read_b64 v[96:97], v3 offset:24
  s_waitcnt lgkmcnt(0)
  v_add_u32 v97, 7, v97
  v_min_u32 v96, v96, v97
  v_readfirstlane_b32 s41, v97
  s_sub_u32 s15, s15, 1
  v_readfirstlane_b32 s76, v96
  s_cmp_eq_u32 s15, 0
  s_cbranch_scc1 VR_12
  s_cmp_gt_u32 s76, 1
  s_cbranch_scc0 VW_11
VR_12:
  ds_read_b64_tr_b16 v[136:137], v126 offset:8192
  ds_read_b64_tr_b16 v[138:139], v126 offset:9216
  ds_read_b64_tr_b16 v[140:141], v127 offset:8192
  ds_read_b64_tr_b16 v[142:143], v127 offset:9216
  s_cmp_gt_u32 s76, 2
  s_cbranch_scc1 VR_14
  s_mov_b32 s15, 0x400000
VW_13:
  ds_read_b64 v[96:97], v3 offset:24
  s_waitcnt lgkmcnt(0)
  v_add_u32 v97, 7, v97
  v_min_u32 v96, v96, v97
  v_readfirstlane_b32 s41, v97
  s_sub_u32 s15, s15, 1
  v_readfirstlane_b32 s76, v96
  s_cmp_eq_u32 s15, 0
  s_cbranch_scc1 VR_14
  s_cmp_gt_u32 s76, 2
  s_cbranch_scc0 VW_13
VR_14:
  ds_read_b64_tr_b16 v[144:145], v126 offset:16384
  ds_read_b64_tr_b16 v[146:147], v126 offset:17408
  ds_read_b64_tr_b16 v[148:149], v127 offset:16384
  ds_read_b64_tr_b16 v[150:151], v127 offset:17408
  s_waitcnt lgkmcnt(8)
  v_mfma_f32_16x16x32_bf16 v[64:67], v[128:131], v[16:19], 0
  v_mfma_f32_16x16x32_bf16 v[68:71], v[132:135], v[16:19], 0
  s_cmp_gt_u32 s76, 3
  s_cbranch_scc1 VR_16
  s_mov_b32 s15, 0x400000
VW_15:
  ds_read_b64 v[96:97], v3 offset:24
  s_waitcnt lgkmcnt(0)
  v_add_u32 v97, 7, v97
  v_min_u32 v96, v96, v97
  v_readfirstlane_b32 s41, v97
  s_sub_u32 s15, s15, 1
  v_readfirstlane_b32 s76, v96
  s_cmp_eq_u32 s15, 0
  s_cbranch_scc1 VR_16
  s_cmp_gt_u32 s76, 3
  s_cbranch_scc0 VW_15
VR_16:
  ds_read_b64_tr_b16 v[152:153], v126 offset:24576
  ds_read_b64_tr_b16 v[154:155], v126 offset:25600
  ds_read_b64_tr_b16 v[156:157], v127 offset:24576
  ds_read_b64_tr_b16 v[158:159], v127 offset:25600
  s_waitcnt lgkmcnt(8)
  v_mfma_f32_16x16x32_bf16 v[64:67], v[136:139], v[20:23], v[64:67]
  v_mfma_f32_16x16x32_bf16 v[68:71], v[140:143], v[20:23], v[68:71]
  s_cmp_gt_u32 s76, 4
  s_cbranch_scc1 VR_18
  s_mov_b32 s15, 0x400000
VW_17:
  ds_read_b64 v[96:97], v3 offset:24
  s_waitcnt lgkmcnt(0)
  v_add_u32 v97, 7, v97
  v_min_u32 v96, v96, v97
  v_readfirstlane_b32 s41, v97
  s_sub_u32 s15, s15, 1
  v_readfirstlane_b32 s76, v96
  s_cmp_eq_u32 s15, 0
  s_cbranch_scc1 VR_18
  s_cmp_gt_u32 s76, 4
  s_cbranch_scc0 VW_17
VR_18:
  ds_read_b64_tr_b16 v[128:129], v126 offset:32768
  ds_read_b64_tr_b16 v[130:131], v126 offset:33792
  ds_read_b64_tr_b16 v[132:133], v127 offset:32768
  ds_read_b64_tr_b16 v[134:135], v127 offset:33792
  s_waitcnt lgkmcnt(8)
  v_mfma_f32_16x16x32_bf16 v[64:67], v[144:147], v[24:27], v[64:67]
  v_mfma_f32_16x16x32_bf16 v[68:71], v[148:151], v[24:27], v[68:71]
  s_cmp_gt_u32 s76, 5
  s_cbranch_scc1 VR_20
  s_mov_b32 s15, 0x400000
VW_19:
  ds_read_b64 v[96:97], v3 offset:24
  s_waitcnt lgkmcnt(0)
  v_add_u32 v97, 7, v97
  v_min_u32 v96, v96, v97
  v_readfirstlane_b32 s41, v97
  s_sub_u32 s15, s15, 1
  v_readfirstlane_b32 s76, v96
  s_cmp_eq_u32 s15, 0
  s_cbranch_scc1 VR_20
  s_cmp_gt_u32 s76, 5
  s_cbranch_scc0 VW_19
VR_20:
  ds_read_b64_tr_b16 v[136:137], v126 offset:40960
  ds_read_b64_tr_b16 v[138:139], v126 offset:41984
  ds_read_b64_tr_b16 v[140:141], v127 offset:40960
  ds_read_b64_tr_b16 v[142:143], v127 offset:41984
  s_waitcnt lgkmcnt(8)
  v_mfma_f32_16x16x32_bf16 v[64:67], v[152:155], v[28:31], v[64:67]
  v_mfma_f32_16x16x32_bf16 v[68:71], v[156:159], v[28:31], v[68:71]
  s_cmp_gt_u32 s76, 6
  s_cbranch_scc1 VR_22
  s_mov_b32 s15, 0x400000
VW_21:
  ds_read_b64 v[96:97], v3 offset:24
  s_waitcnt lgkmcnt(0)
  v_add_u32 v97, 7, v97
  v_min_u32 v96, v96, v97
  v_readfirstlane_b32 s41, v97
  s_sub_u32 s15, s15, 1
  v_readfirstlane_b32 s76, v96
  s_cmp_eq_u32 s15, 0
  s_cbranch_scc1 VR_22
  s_cmp_gt_u32 s76, 6
  s_cbranch_scc0 VW_21
VR_22:
  ds_read_b64_tr_b16 v[144:145], v126 offset:49152
  ds_read_b64_tr_b16 v[146:147], v126 offset:50176
  ds_read_b64_tr_b16 v[148:149], v127 offset:49152
  ds_read_b64_tr_b16 v[150:151], v127 offset:50176
  s_waitcnt lgkmcnt(8)
  v_mfma_f32_16x16x32_bf16 v[64:67], v[128:131], v[32:35], v[64:67]
  v_mfma_f32_16x16x32_bf16 v[68:71], v[132:135], v[32:35], v[68:71]
  s_cmp_gt_u32 s76, 7
  s_cbranch_scc1 VR_24
  s_mov_b32 s15, 0x400000
VW_23:
  ds_read_b64 v[96:97], v3 offset:24
  s_waitcnt lgkmcnt(0)
  v_add_u32 v97, 7, v97
  v_min_u32 v96, v96, v97
  v_readfirstlane_b32 s41, v97
  s_sub_u32 s15, s15, 1
  v_readfirstlane_b32 s76, v96
  s_cmp_eq_u32 s15, 0
  s_cbranch_scc1 VR_24
  s_cmp_gt_u32 s76, 7
  s_cbranch_scc0 VW_23
VR_24:
  ds_read_b64_tr_b16 v[152:153], v126 offset:57344
  ds_read_b64_tr_b16 v[154:155], v126 offset:58368
  ds_read_b64_tr_b16 v[156:157], v127 offset:57344
  ds_read_b64_tr_b16 v[158:159], v127 offset:58368
  s_waitcnt lgkmcnt(8)
  v_mfma_f32_16x16x32_bf16 v[64:67], v[136:139], v[36:39], v[64:67]
  v_mfma_f32_16x16x32_bf16 v[68:71], v[140:143], v[36:39], v[68:71]
  s_cmp_eq_u32 s41, 8
  s_cselect_b32 s67, s67, s77
  s_cselect_b32 s40, s40, s65
  s_cselect_b64 s[42:43], -1, 0
  v_cndmask_b32 v112, v108, v112, s[42:43]
  s_waitcnt lgkmcnt(4)
  v_mfma_f32_16x16x32_bf16 v[64:67], v[144:147], v[40:43], v[64:67]
  v_mfma_f32_16x16x32_bf16 v[68:71], v[148:151], v[40:43], v[68:71]
  s_waitcnt lgkmcnt(0)
  v_mfma_f32_16x16x32_bf16 v[64:67], v[152:155], v[44:47], v[64:67]
  v_mfma_f32_16x16x32_bf16 v[68:71], v[156:159], v[44:47], v[68:71]
  s_mov_b32 exec_lo, 0x000f000f
  s_mov_b32 exec_hi, 0x000f000f
  s_nop 4
  v_cvt_pk_bf16_f32 v72, v64, v65
  v_cvt_pk_bf16_f32 v73, v66, v67
  v_cvt_pk_bf16_f32 v74, v68, v69
  v_cvt_pk_bf16_f32 v75, v70, v71
  v_min_u32 v72, -2, v72
  v_min_u32 v73, -2, v73
  v_min_u32 v74, -2, v74
  v_min_u32 v75, -2, v75
  s_cmp_eq_u32 s41, 8
  s_cbranch_scc0 L_oglob
  buffer_store_dwordx4 v[72:75], v125, s[52:55], s66 offen
  s_mov_b64 exec, 1
  buffer_store_dwordx2 v[114:115], v3, s[52:55], s36 offen
  s_branch L_ostored
L_oglob:
  buffer_store_dwordx4 v[72:75], v125, s[52:55], s79 offen sc1
L_ostored:
  s_mov_b64 exec, -1
  s_mov_b32 s15, 0x40000
PL_25:
  buffer_load_dwordx2 v[76:77], v112, s[52:55], s40 offen sc1
PC_27:
  s_waitcnt vmcnt(0)
  v_max3_u32 v10, v76, v77, v77
  v_cmp_eq_u32 vcc, -1, v10
  s_and_b64 exec, exec, vcc
  s_cbranch_scc0 PD_26
  s_sub_u32 s15, s15, 1
  s_cmp_lg_u32 s15, 0
  s_cbranch_scc1 PL_25
PD_26:
  s_mov_b64 exec, -1
  buffer_load_dwordx4 v[64:67], v102, s[52:55], s67 offen sc1
  buffer_load_dwordx4 v[68:71], v102, s[52:55], s67 offen offset:256 sc1
  v_mov_b32 v78, v76
  v_mov_b32 v79, v78
  s_nop 1
  v_permlane16_swap_b32 v78, v79
  s_nop 0
  v_max_f32 v78, v78, v79
  v_mov_b32 v79, v78
  s_nop 1
  v_permlane32_swap_b32 v78, v79
  s_nop 0
  v_max_f32 v78, v78, v79
  v_sub_f32 v76, v76, v78
  v_exp_f32 v76, v76
  s_nop 0
  v_mul_f32 v77, v76, v77
  ds_bpermute_b32 v76, v103, v76
  v_mov_b32 v79, v77
  s_nop 1
  v_permlane16_swap_b32 v77, v79
  s_nop 0
  v_add_f32 v77, v77, v79
  v_mov_b32 v79, v77
  s_nop 1
  v_permlane32_swap_b32 v77, v79
  s_nop 0
  v_add_f32 v77, v77, v79
  v_rcp_f32 v77, v77
  s_waitcnt lgkmcnt(0)
  v_mul_f32 v76, v76, v77
  v_mov_b32 v77, v76
  s_mov_b32 s15, 0x400000
FW_28:
  ds_read_b32 v10, v3 offset:40
  s_waitcnt lgkmcnt(0)
  v_readfirstlane_b32 s14, v10
  s_cmp_ge_u32 s14, 1
  s_cbranch_scc1 FD_29
  s_sub_u32 s15, s15, 1
  s_cmp_lg_u32 s15, 0
  s_cbranch_scc1 FW_28
FD_29:
  ds_read_b64_tr_b16 v[48:49], v101 offset:6144
  ds_read_b64_tr_b16 v[50:51], v101 offset:8192
  ds_read_b64_tr_b16 v[52:53], v101 offset:10240
  ds_read_b64_tr_b16 v[54:55], v101 offset:12288
  ds_read_b64_tr_b16 v[56:57], v109 offset:6144
  ds_read_b64_tr_b16 v[58:59], v109 offset:8192
  ds_read_b64_tr_b16 v[60:61], v109 offset:10240
  ds_read_b64_tr_b16 v[62:63], v109 offset:12288
  ds_read_b64_tr_b16 v[80:81], v110 offset:6144
  ds_read_b64_tr_b16 v[82:83], v110 offset:8192
  ds_read_b64_tr_b16 v[84:85], v110 offset:10240
  ds_read_b64_tr_b16 v[86:87], v110 offset:12288
  ds_read_b64_tr_b16 v[88:89], v111 offset:6144
  ds_read_b64_tr_b16 v[90:91], v111 offset:8192
  ds_read_b64_tr_b16 v[92:93], v111 offset:10240
  ds_read_b64_tr_b16 v[94:95], v111 offset:12288
  s_mov_b32 s15, 0x40000
  s_branch PC_32
PL_30:
  buffer_load_dwordx4 v[64:67], v102, s[52:55], s67 offen sc1
  buffer_load_dwordx4 v[68:71], v102, s[52:55], s67 offen offset:256 sc1
PC_32:
  s_waitcnt vmcnt(0)
  v_max3_u32 v10, v64, v65, v66
  v_max3_u32 v10, v10, v67, v68
  v_max3_u32 v10, v10, v69, v70
  v_max_u32 v10, v10, v71
  v_cmp_eq_u32 vcc, -1, v10
  s_and_b64 exec, exec, vcc
  s_cbranch_scc0 PD_31
  s_sub_u32 s15, s15, 1
  s_cmp_lg_u32 s15, 0
  s_cbranch_scc1 PL_30
PD_31:
  s_mov_b64 exec, -1
  s_waitcnt lgkmcnt(0)
  v_mfma_f32_16x16x32_bf16 v[16:19], v[48:51], v[64:67], 0
  v_mfma_f32_16x16x32_bf16 v[20:23], v[56:59], v[64:67], 0
  v_mfma_f32_16x16x32_bf16 v[24:27], v[80:83], v[64:67], 0
  v_mfma_f32_16x16x32_bf16 v[28:31], v[88:91], v[64:67], 0
  v_mfma_f32_16x16x32_bf16 v[16:19], v[52:55], v[68:71], v[16:19]
  v_mfma_f32_16x16x32_bf16 v[20:23], v[60:63], v[68:71], v[20:23]
  v_mfma_f32_16x16x32_bf16 v[24:27], v[84:87], v[68:71], v[24:27]
  v_mfma_f32_16x16x32_bf16 v[28:31], v[92:95], v[68:71], v[28:31]
  s_nop 4
  v_pk_mul_f32 v[16:17], v[16:17], v[76:77]
  v_pk_mul_f32 v[18:19], v[18:19], v[76:77]
  ds_write_b128 v104, v[16:19] offset:30720
  v_pk_mul_f32 v[20:21], v[20:21], v[76:77]
  v_pk_mul_f32 v[22:23], v[22:23], v[76:77]
  ds_write_b128 v104, v[20:23] offset:30784
  v_pk_mul_f32 v[24:25], v[24:25], v[76:77]
  v_pk_mul_f32 v[26:27], v[26:27], v[76:77]
  ds_write_b128 v104, v[24:27] offset:30848
  v_pk_mul_f32 v[28:29], v[28:29], v[76:77]
  v_pk_mul_f32 v[30:31], v[30:31], v[76:77]
  ds_write_b128 v104, v[28:31] offset:30912
  s_waitcnt lgkmcnt(0)
  s_barrier
  ds_read_b64 v[32:33], v106 offset:30720
  ds_read_b64 v[34:35], v106 offset:32896
  ds_read_b64 v[36:37], v106 offset:35072
  ds_read_b64 v[38:39], v106 offset:37248
  ds_read_b64 v[40:41], v106 offset:39424
  ds_read_b64 v[42:43], v106 offset:41600
  ds_read_b64 v[44:45], v106 offset:43776
  ds_read_b64 v[46:47], v106 offset:45952
  s_waitcnt lgkmcnt(4)
  v_pk_add_f32 v[32:33], v[32:33], v[34:35]
  v_pk_add_f32 v[36:37], v[36:37], v[38:39]
  v_pk_add_f32 v[32:33], v[32:33], v[36:37]
  s_waitcnt lgkmcnt(0)
  v_pk_add_f32 v[40:41], v[40:41], v[42:43]
  v_pk_add_f32 v[44:45], v[44:45], v[46:47]
  v_pk_add_f32 v[40:41], v[40:41], v[44:45]
  v_pk_add_f32 v[32:33], v[32:33], v[40:41]
  v_cvt_pk_bf16_f32 v32, v32, v33
  v_min_u32 v32, -2, v32
  s_nop 1
  v_mov_b32_dpp v33, v32 quad_perm:[1,1,1,1] row_mask:0xf bank_mask:0xf
  v_mov_b32_dpp v34, v32 quad_perm:[2,2,2,2] row_mask:0xf bank_mask:0xf
  v_mov_b32_dpp v35, v32 quad_perm:[3,3,3,3] row_mask:0xf bank_mask:0xf
  s_mov_b32 exec_lo, 0x11111111
  s_mov_b32 exec_hi, 0x11111111
  buffer_store_dwordx4 v[32:35], v105, s[52:55], s78 offen sc1
  s_mov_b64 exec, -1
  s_branch L_fin
L_H:
  s_cmp_eq_u32 s3, 8
  s_cbranch_scc1 L_load
  s_setprio 3
  v_lshlrev_b32 v7, 4, v2
  s_sub_u32 s77, s3, 4
  s_cmp_lg_u32 s3, 7
  s_cbranch_scc1 L_noinit
  v_lshlrev_b32 v8, 2, v5
  ds_write_b32 v8, v3
L_noinit:
  v_lshrrev_b32 v8, 3, v2
  v_and_b32 v9, 7, v2
  v_lshlrev_b32 v9, 4, v9
  s_lshl_b32 s68, s77, 11
  s_mov_b32 s69, 0x1b8000
  s_waitcnt lgkmcnt(0)
  s_load_dword s79, s[26:27], s69
  s_mov_b32 s32, s8
  s_mov_b32 s33, s9
  s_mov_b32 s44, s12
  s_mov_b32 s45, s13
  s_mov_b32 s48, s20
  s_mov_b32 s49, s21
  s_mov_b32 s52, s26
  s_mov_b32 s53, s27
  s_mov_b32 s56, s4
  s_mov_b32 s57, s5
  buffer_load_dwordx4 v[16:19], v7, s[56:59], s68 offen offset:0
  buffer_load_dwordx4 v[20:23], v7, s[56:59], s68 offen offset:1024
  s_cmp_ge_u32 s3, 6
  s_cbranch_scc1 L_SX0
  s_cmp_eq_u32 s3, 5
  s_cbranch_scc1 L_G1
  s_mov_b32 s36, s10
  s_mov_b32 s37, s11
  s_mov_b32 s38, 4194304
  s_lshl_b32 s76, s70, 3
  s_add_u32 s76, s76, s72
  s_lshl_b32 s76, s76, 7
  s_movk_i32 s69, 8192
  s_lshl_b32 s78, s73, 17
  s_lshl_b32 s68, s76, 4
  s_add_u32 s78, s78, s68
  s_add_u32 s78, s78, 0
  s_branch L_GJ
L_G1:
  s_cmp_eq_u32 s70, 7
  s_cbranch_scc1 L_LN0
  s_bitcmp1_b32 s71, 2
  s_cselect_b32 s36, s18, s16
  s_cselect_b32 s37, s19, s17
  s_mov_b32 s38, 1835008
  s_lshl_b32 s76, s74, 7
  s_movk_i32 s69, 3584
  s_and_b32 s78, s71, 7
  s_mul_i32 s78, s78, 57344
  s_lshl_b32 s68, s76, 4
  s_add_u32 s78, s78, s68
  s_add_u32 s78, s78, 524288
L_GJ:
  v_mul_lo_u32 v10, v8, s69
  v_add_u32 v10, v10, v9
  s_lshl_b32 s68, s73, 7
  s_mul_i32 s68, s68, s69
  s_add_u32 s100, s76, s68
  s_lshl_b32 s101, s69, 3
  s_lshl_b32 s68, s77, 14
  s_add_u32 s68, s68, 30720
  s_mov_b32 m0, s68
  s_add_u32 s68, s68, 1024
  buffer_load_dwordx4 v10, s[36:39], s100 offen nt lds
  s_add_u32 s100, s100, s101
  s_mov_b32 m0, s68
  s_add_u32 s68, s68, 1024
  buffer_load_dwordx4 v10, s[36:39], s100 offen nt lds
  s_add_u32 s100, s100, s101
  s_mov_b32 m0, s68
  s_add_u32 s68, s68, 1024
  buffer_load_dwordx4 v10, s[36:39], s100 offen nt lds
  s_add_u32 s100, s100, s101
  s_mov_b32 m0, s68
  s_add_u32 s68, s68, 1024
  buffer_load_dwordx4 v10, s[36:39], s100 offen nt lds
  s_add_u32 s100, s100, s101
  s_mov_b32 m0, s68
  s_add_u32 s68, s68, 1024
  buffer_load_dwordx4 v10, s[36:39], s100 offen nt lds
  s_add_u32 s100, s100, s101
  s_mov_b32 m0, s68
  s_add_u32 s68, s68, 1024
  buffer_load_dwordx4 v10, s[36:39], s100 offen nt lds
  s_add_u32 s100, s100, s101
  s_mov_b32 m0, s68
  s_add_u32 s68, s68, 1024
  buffer_load_dwordx4 v10, s[36:39], s100 offen nt lds
  s_add_u32 s100, s100, s101
  s_mov_b32 m0, s68
  s_add_u32 s68, s68, 1024
  buffer_load_dwordx4 v10, s[36:39], s100 offen nt lds
  s_add_u32 s100, s100, s101
  s_mov_b32 m0, s68
  s_add_u32 s68, s68, 1024
  buffer_load_dwordx4 v10, s[36:39], s100 offen nt lds
  s_add_u32 s100, s100, s101
  s_mov_b32 m0, s68
  s_add_u32 s68, s68, 1024
  buffer_load_dwordx4 v10, s[36:39], s100 offen nt lds
  s_add_u32 s100, s100, s101
  s_mov_b32 m0, s68
  s_add_u32 s68, s68, 1024
  buffer_load_dwordx4 v10, s[36:39], s100 offen nt lds
  s_add_u32 s100, s100, s101
  s_mov_b32 m0, s68
  s_add_u32 s68, s68, 1024
  buffer_load_dwordx4 v10, s[36:39], s100 offen nt lds
  s_add_u32 s100, s100, s101
  s_mov_b32 m0, s68
  s_add_u32 s68, s68, 1024
  buffer_load_dwordx4 v10, s[36:39], s100 offen nt lds
  s_add_u32 s100, s100, s101
  s_mov_b32 m0, s68
  s_add_u32 s68, s68, 1024
  buffer_load_dwordx4 v10, s[36:39], s100 offen nt lds
  s_add_u32 s100, s100, s101
  s_mov_b32 m0, s68
  s_add_u32 s68, s68, 1024
  buffer_load_dwordx4 v10, s[36:39], s100 offen nt lds
  s_add_u32 s100, s100, s101
  s_mov_b32 m0, s68
  s_add_u32 s68, s68, 1024
  buffer_load_dwordx4 v10, s[36:39], s100 offen nt lds
  s_add_u32 s100, s100, s101
  s_barrier
  s_waitcnt vmcnt(16)
  s_branch L_LN
L_SX0:
  s_cmp_eq_u32 s3, 7
  s_cbranch_scc1 L_LN0
  v_mov_b32 v24, -1
  v_mov_b32 v25, -1
  v_mov_b32 v26, -1
  v_mov_b32 v27, -1
  s_lshl_b32 s68, s70, 2
  s_add_u32 s68, s68, s73
  s_lshl_b32 s68, s68, 3
  s_add_u32 s68, s68, s72
  s_lshl_b32 s68, s68, 10
  s_add_u32 s68, s68, 983040
  buffer_store_dwordx4 v[24:27], v7, s[52:55], s68 offen sc1
  s_add_u32 s68, s68, 2097152
  buffer_store_dwordx4 v[24:27], v7, s[52:55], s68 offen sc1
  v_lshl_add_u32 v10, v8, 10, v9
  s_lshl_b32 s68, s74, 13
  s_lshl_b32 s69, s75, 7
  s_add_u32 s68, s68, s69
  s_add_u32 s69, s68, 1253376
  buffer_store_dwordx4 v[24:27], v10, s[52:55], s69 offen sc1
  s_cmp_eq_u32 s70, 7
  s_cbranch_scc1 L_nofp
  s_mov_b32 s68, s74
  s_mov_b32 s69, s75
  s_lshl_b32 s68, s68, 13
  s_lshl_b32 s69, s69, 7
  s_add_u32 s69, s69, s68
  s_add_u32 s69, s69, 1515520
  buffer_store_dwordx4 v[24:27], v10, s[52:55], s69 offen sc1
L_nofp:
  s_lshl_b32 s68, s70, 5
  s_add_u32 s68, s68, s71
  s_lshl_b32 s68, s68, 7
  s_add_u32 s68, s68, 1835008
  s_mov_b64 exec, 3
  buffer_store_dwordx4 v[24:27], v7, s[52:55], s68 offen sc1
  s_mov_b64 exec, 15
  v_lshlrev_b32 v10, 8, v2
  s_lshl_b32 s68, s70, 10
  s_lshl_b32 s69, s71, 3
  s_add_u32 s68, s68, s69
  s_add_u32 s68, s68, 4063232
  buffer_store_dwordx2 v[24:25], v10, s[52:55], s68 offen sc1
  s_mov_b64 exec, -1
  s_barrier
  s_waitcnt vmcnt(5)
  s_cmp_eq_u32 s70, 7
  s_cbranch_scc1 L_LN
  s_nop 0
  s_branch L_LN
L_LN0:
  s_barrier
  s_waitcnt vmcnt(0)
L_LN:
  v_lshlrev_b32 v32, 16, v16
  v_and_b32 v33, 0xffff0000, v16
  v_lshlrev_b32 v34, 16, v17
  v_and_b32 v35, 0xffff0000, v17
  v_lshlrev_b32 v36, 16, v18
  v_and_b32 v37, 0xffff0000, v18
  v_lshlrev_b32 v38, 16, v19
  v_and_b32 v39, 0xffff0000, v19
  v_lshlrev_b32 v40, 16, v20
  v_and_b32 v41, 0xffff0000, v20
  v_lshlrev_b32 v42, 16, v21
  v_and_b32 v43, 0xffff0000, v21
  v_lshlrev_b32 v44, 16, v22
  v_and_b32 v45, 0xffff0000, v22
  v_lshlrev_b32 v46, 16, v23
  v_and_b32 v47, 0xffff0000, v23
  v_add_f32 v64, v32, v33
  v_add_f32 v66, v34, v35
  v_add_f32 v65, v40, v41
  v_add_f32 v67, v42, v43
  v_add_f32 v64, v64, v36
  v_add_f32 v66, v66, v37
  v_add_f32 v65, v65, v44
  v_add_f32 v67, v67, v45
  v_add_f32 v64, v64, v38
  v_add_f32 v66, v66, v39
  v_add_f32 v65, v65, v46
  v_add_f32 v67, v67, v47
  v_add_f32 v64, v64, v66
  v_add_f32 v65, v65, v67
  s_nop 0
  v_add_f32_dpp v64, v64, v64 quad_perm:[1,0,3,2] row_mask:0xf bank_mask:0xf
  v_add_f32_dpp v65, v65, v65 quad_perm:[1,0,3,2] row_mask:0xf bank_mask:0xf
  s_nop 0
  v_add_f32_dpp v64, v64, v64 quad_perm:[2,3,0,1] row_mask:0xf bank_mask:0xf
  v_add_f32_dpp v65, v65, v65 quad_perm:[2,3,0,1] row_mask:0xf bank_mask:0xf
  s_nop 0
  v_add_f32_dpp v64, v64, v64 row_half_mirror row_mask:0xf bank_mask:0xf
  v_add_f32_dpp v65, v65, v65 row_half_mirror row_mask:0xf bank_mask:0xf
  s_nop 0
  v_add_f32_dpp v64, v64, v64 row_mirror row_mask:0xf bank_mask:0xf
  v_add_f32_dpp v65, v65, v65 row_mirror row_mask:0xf bank_mask:0xf
  v_mov_b32 v68, v64
  v_mov_b32 v69, v65
  s_nop 1
  v_permlane16_swap_b32 v64, v68
  v_permlane16_swap_b32 v65, v69
  s_nop 0
  v_add_f32 v64, v64, v68
  v_add_f32 v65, v65, v69
  v_mov_b32 v68, v64
  v_mov_b32 v69, v65
  s_nop 1
  v_permlane32_swap_b32 v64, v68
  v_permlane32_swap_b32 v65, v69
  s_nop 0
  v_add_f32 v64, v64, v68
  v_add_f32 v65, v65, v69
  s_mov_b32 s68, 0x3b000000
  v_mul_f32 v64, s68, v64
  v_mul_f32 v65, s68, v65
  v_sub_f32 v80, v32, v64
  v_sub_f32 v81, v40, v65
  v_mul_f32 v72, v80, v80
  v_mul_f32 v73, v81, v81
  v_sub_f32 v82, v33, v64
  v_sub_f32 v83, v41, v65
  v_fmac_f32 v72, v82, v82
  v_fmac_f32 v73, v83, v83
  v_sub_f32 v80, v34, v64
  v_sub_f32 v81, v42, v65
  v_fmac_f32 v72, v80, v80
  v_fmac_f32 v73, v81, v81
  v_sub_f32 v82, v35, v64
  v_sub_f32 v83, v43, v65
  v_fmac_f32 v72, v82, v82
  v_fmac_f32 v73, v83, v83
  v_sub_f32 v80, v36, v64
  v_sub_f32 v81, v44, v65
  v_fmac_f32 v72, v80, v80
  v_fmac_f32 v73, v81, v81
  v_sub_f32 v82, v37, v64
  v_sub_f32 v83, v45, v65
  v_fmac_f32 v72, v82, v82
  v_fmac_f32 v73, v83, v83
  v_sub_f32 v80, v38, v64
  v_sub_f32 v81, v46, v65
  v_fmac_f32 v72, v80, v80
  v_fmac_f32 v73, v81, v81
  v_sub_f32 v82, v39, v64
  v_sub_f32 v83, v47, v65
  v_fmac_f32 v72, v82, v82
  v_fmac_f32 v73, v83, v83
  s_nop 0
  v_add_f32_dpp v72, v72, v72 quad_perm:[1,0,3,2] row_mask:0xf bank_mask:0xf
  v_add_f32_dpp v73, v73, v73 quad_perm:[1,0,3,2] row_mask:0xf bank_mask:0xf
  s_nop 0
  v_add_f32_dpp v72, v72, v72 quad_perm:[2,3,0,1] row_mask:0xf bank_mask:0xf
  v_add_f32_dpp v73, v73, v73 quad_perm:[2,3,0,1] row_mask:0xf bank_mask:0xf
  s_nop 0
  v_add_f32_dpp v72, v72, v72 row_half_mirror row_mask:0xf bank_mask:0xf
  v_add_f32_dpp v73, v73, v73 row_half_mirror row_mask:0xf bank_mask:0xf
  s_nop 0
  v_add_f32_dpp v72, v72, v72 row_mirror row_mask:0xf bank_mask:0xf
  v_add_f32_dpp v73, v73, v73 row_mirror row_mask:0xf bank_mask:0xf
  v_mov_b32 v76, v72
  v_mov_b32 v77, v73
  s_nop 1
  v_permlane16_swap_b32 v72, v76
  v_permlane16_swap_b32 v73, v77
  s_nop 0
  v_add_f32 v72, v72, v76
  v_add_f32 v73, v73, v77
  v_mov_b32 v76, v72
  v_mov_b32 v77, v73
  s_nop 1
  v_permlane32_swap_b32 v72, v76
  v_permlane32_swap_b32 v73, v77
  s_nop 0
  v_add_f32 v72, v72, v76
  v_add_f32 v73, v73, v77
  v_mul_f32 v72, s68, v72
  v_mul_f32 v73, s68, v73
  v_cvt_pk_bf16_f32 v64, v64, v64
  v_cvt_pk_bf16_f32 v65, v65, v65
  v_cvt_pk_bf16_f32 v72, v72, v72
  v_cvt_pk_bf16_f32 v73, v73, v73
  v_and_b32 v64, 0xffff0000, v64
  v_and_b32 v65, 0xffff0000, v65
  v_and_b32 v72, 0xffff0000, v72
  v_and_b32 v73, 0xffff0000, v73
  v_add_f32 v72, 0x3727c5ac, v72
  v_add_f32 v73, 0x3727c5ac, v73
  v_cvt_pk_bf16_f32 v72, v72, v72
  v_cvt_pk_bf16_f32 v73, v73, v73
  v_and_b32 v72, 0xffff0000, v72
  v_and_b32 v73, 0xffff0000, v73
  v_sqrt_f32 v72, v72
  v_sqrt_f32 v73, v73
  s_nop 0
  v_cvt_pk_bf16_f32 v72, v72, v72
  v_cvt_pk_bf16_f32 v73, v73, v73
  v_and_b32 v72, 0xffff0000, v72
  v_and_b32 v73, 0xffff0000, v73
  v_rcp_f32 v72, v72
  v_rcp_f32 v73, v73
  v_sub_f32 v32, v32, v64
  v_sub_f32 v33, v33, v64
  v_sub_f32 v34, v34, v64
  v_sub_f32 v35, v35, v64
  v_sub_f32 v36, v36, v64
  v_sub_f32 v37, v37, v64
  v_sub_f32 v38, v38, v64
  v_sub_f32 v39, v39, v64
  v_sub_f32 v40, v40, v65
  v_sub_f32 v41, v41, v65
  v_sub_f32 v42, v42, v65
  v_sub_f32 v43, v43, v65
  v_sub_f32 v44, v44, v65
  v_sub_f32 v45, v45, v65
  v_sub_f32 v46, v46, v65
  v_sub_f32 v47, v47, v65
  v_cvt_pk_bf16_f32 v16, v32, v33
  v_cvt_pk_bf16_f32 v17, v34, v35
  v_cvt_pk_bf16_f32 v18, v36, v37
  v_cvt_pk_bf16_f32 v19, v38, v39
  v_cvt_pk_bf16_f32 v20, v40, v41
  v_cvt_pk_bf16_f32 v21, v42, v43
  v_cvt_pk_bf16_f32 v22, v44, v45
  v_cvt_pk_bf16_f32 v23, v46, v47
  v_lshlrev_b32 v32, 16, v16
  v_and_b32 v33, 0xffff0000, v16
  v_lshlrev_b32 v34, 16, v17
  v_and_b32 v35, 0xffff0000, v17
  v_lshlrev_b32 v36, 16, v18
  v_and_b32 v37, 0xffff0000, v18
  v_lshlrev_b32 v38, 16, v19
  v_and_b32 v39, 0xffff0000, v19
  v_lshlrev_b32 v40, 16, v20
  v_and_b32 v41, 0xffff0000, v20
  v_lshlrev_b32 v42, 16, v21
  v_and_b32 v43, 0xffff0000, v21
  v_lshlrev_b32 v44, 16, v22
  v_and_b32 v45, 0xffff0000, v22
  v_lshlrev_b32 v46, 16, v23
  v_and_b32 v47, 0xffff0000, v23
  v_mul_f32 v32, v32, v72
  v_mul_f32 v33, v33, v72
  v_mul_f32 v34, v34, v72
  v_mul_f32 v35, v35, v72
  v_mul_f32 v36, v36, v72
  v_mul_f32 v37, v37, v72
  v_mul_f32 v38, v38, v72
  v_mul_f32 v39, v39, v72
  v_mul_f32 v40, v40, v73
  v_mul_f32 v41, v41, v73
  v_mul_f32 v42, v42, v73
  v_mul_f32 v43, v43, v73
  v_mul_f32 v44, v44, v73
  v_mul_f32 v45, v45, v73
  v_mul_f32 v46, v46, v73
  v_mul_f32 v47, v47, v73
  v_cvt_pk_bf16_f32 v16, v32, v33
  v_cvt_pk_bf16_f32 v17, v34, v35
  v_cvt_pk_bf16_f32 v18, v36, v37
  v_cvt_pk_bf16_f32 v19, v38, v39
  v_cvt_pk_bf16_f32 v20, v40, v41
  v_cvt_pk_bf16_f32 v21, v42, v43
  v_cvt_pk_bf16_f32 v22, v44, v45
  v_cvt_pk_bf16_f32 v23, v46, v47
  s_mul_i32 s68, s77, 544
  v_lshlrev_b32 v11, 4, v5
  v_add_u32 v11, s68, v11
  v_cmp_eq_u32 vcc, s73, v6
  s_and_saveexec_b64 s[68:69], vcc
  ds_write_b128 v11, v[16:19] offset:256
  ds_write_b128 v11, v[20:23] offset:528
  s_waitcnt lgkmcnt(0)
  s_mov_b64 exec, 1
  ds_add_u32 v3, v4 offset:0
  s_mov_b64 exec, -1
  s_add_u32 s4, s79, 1
  s_mul_i32 s5, s4, 0x9e3779b1
  v_lshrrev_b32 v12, 2, v5
  v_lshl_add_u32 v12, v6, 3, v12
  v_lshlrev_b32 v12, 7, v12
  v_and_b32 v13, 3, v2
  v_and_b32 v14, 7, v2
  s_cmp_ge_u32 s3, 6
  s_cbranch_scc1 L_SX1
  s_cmp_lg_u32 s3, 5
  s_cbranch_scc1 L_Ggo
  s_cmp_lg_u32 s70, 7
  s_cbranch_scc1 L_Ggo
  s_waitcnt lgkmcnt(0)
  s_mov_b64 exec, 1
  ds_add_u32 v3, v4 offset:8
  s_mov_b64 exec, -1
  s_waitcnt lgkmcnt(0)
  s_mov_b64 exec, 1
  ds_add_u32 v3, v4 offset:52
  s_mov_b64 exec, -1
  s_waitcnt lgkmcnt(0)
  s_mov_b64 exec, 1
  ds_add_u32 v3, v4 offset:32
  s_mov_b64 exec, -1
  s_branch L_G1post
L_Ggo:
  v_mul_u32_u24 v11, 272, v14
  v_lshl_add_u32 v11, v6, 4, v11
  v_lshl_add_u32 v12, v13, 3, v12
  s_lshl_b32 s68, s77, 14
  v_add_u32 v12, s68, v12
  s_cmp_eq_u32 s3, 5
  s_cbranch_scc1 L_dstG
  v_lshlrev_b32 v15, 8, v14
  v_lshl_add_u32 v15, v6, 4, v15
  s_mov_b32 s8, s78
  s_add_u32 s9, s78, 64
  s_add_u32 s10, s78, 128
  s_add_u32 s11, s78, 192
  v_bfe_u32 v9, v2, 3, 1
  v_lshl_add_u32 v15, v9, 6, v15
  s_branch L_dstJ
L_dstG:
  v_and_b32 v15, 1, v6
  v_lshlrev_b32 v15, 10, v15
  v_lshrrev_b32 v9, 1, v6
  v_lshl_add_u32 v15, v9, 8, v15
  v_lshl_add_u32 v15, v14, 4, v15
  s_mov_b32 s8, s78
  s_add_u32 s9, s78, 512
  s_add_u32 s10, s78, 128
  s_add_u32 s11, s78, 640
  v_bfe_u32 v9, v2, 3, 1
  v_lshl_add_u32 v15, v9, 9, v15
L_dstJ:
  v_mov_b32 v113, s4
  v_mov_b32 v115, s5
  v_mov_b32 v117, s4
  v_mov_b32 v119, s5
  v_mov_b32 v121, s4
  v_mov_b32 v123, s5
  v_mov_b32 v125, s4
  v_mov_b32 v127, s5
  s_add_u32 s66, s78, 2097152
  s_mov_b32 s15, 0x400000
FW_33:
  ds_read_b32 v10, v3 offset:0
  s_waitcnt lgkmcnt(0)
  v_readfirstlane_b32 s14, v10
  s_cmp_ge_u32 s14, 4
  s_cbranch_scc1 FD_34
  s_sleep 1
  s_sub_u32 s15, s15, 1
  s_cmp_lg_u32 s15, 0
  s_cbranch_scc1 FW_33
FD_34:
  ds_read_b128 v[16:19], v11 offset:256
  ds_read_b128 v[20:23], v11 offset:320
  ds_read_b128 v[24:27], v11 offset:384
  ds_read_b128 v[28:31], v11 offset:448
  s_waitcnt vmcnt(12)
  ds_read_b64_tr_b16 v[32:33], v12 offset:30720
  ds_read_b64_tr_b16 v[34:35], v12 offset:31232
  ds_read_b64_tr_b16 v[36:37], v12 offset:30752
  ds_read_b64_tr_b16 v[38:39], v12 offset:31264
  ds_read_b64_tr_b16 v[40:41], v12 offset:30784
  ds_read_b64_tr_b16 v[42:43], v12 offset:31296
  ds_read_b64_tr_b16 v[44:45], v12 offset:30816
  ds_read_b64_tr_b16 v[46:47], v12 offset:31328
  s_waitcnt lgkmcnt(0)
  v_mfma_f32_16x16x32_bf16 v[96:99], v[32:35], v[16:19], 0
  v_mfma_f32_16x16x32_bf16 v[100:103], v[36:39], v[16:19], 0
  v_mfma_f32_16x16x32_bf16 v[104:107], v[40:43], v[16:19], 0
  v_mfma_f32_16x16x32_bf16 v[108:111], v[44:47], v[16:19], 0
  s_waitcnt vmcnt(8)
  ds_read_b64_tr_b16 v[48:49], v12 offset:34816
  ds_read_b64_tr_b16 v[50:51], v12 offset:35328
  ds_read_b64_tr_b16 v[52:53], v12 offset:34848
  ds_read_b64_tr_b16 v[54:55], v12 offset:35360
  ds_read_b64_tr_b16 v[56:57], v12 offset:34880
  ds_read_b64_tr_b16 v[58:59], v12 offset:35392
  ds_read_b64_tr_b16 v[60:61], v12 offset:34912
  ds_read_b64_tr_b16 v[62:63], v12 offset:35424
  s_waitcnt lgkmcnt(0)
  v_mfma_f32_16x16x32_bf16 v[96:99], v[48:51], v[20:23], v[96:99]
  v_mfma_f32_16x16x32_bf16 v[100:103], v[52:55], v[20:23], v[100:103]
  v_mfma_f32_16x16x32_bf16 v[104:107], v[56:59], v[20:23], v[104:107]
  v_mfma_f32_16x16x32_bf16 v[108:111], v[60:63], v[20:23], v[108:111]
  s_waitcnt vmcnt(4)
  ds_read_b64_tr_b16 v[64:65], v12 offset:38912
  ds_read_b64_tr_b16 v[66:67], v12 offset:39424
  ds_read_b64_tr_b16 v[68:69], v12 offset:38944
  ds_read_b64_tr_b16 v[70:71], v12 offset:39456
  ds_read_b64_tr_b16 v[72:73], v12 offset:38976
  ds_read_b64_tr_b16 v[74:75], v12 offset:39488
  ds_read_b64_tr_b16 v[76:77], v12 offset:39008
  ds_read_b64_tr_b16 v[78:79], v12 offset:39520
  s_waitcnt lgkmcnt(0)
  v_mfma_f32_16x16x32_bf16 v[96:99], v[64:67], v[24:27], v[96:99]
  v_mfma_f32_16x16x32_bf16 v[100:103], v[68:71], v[24:27], v[100:103]
  v_mfma_f32_16x16x32_bf16 v[104:107], v[72:75], v[24:27], v[104:107]
  v_mfma_f32_16x16x32_bf16 v[108:111], v[76:79], v[24:27], v[108:111]
  s_waitcnt vmcnt(0)
  s_waitcnt lgkmcnt(0)
  s_mov_b64 exec, 1
  ds_add_u32 v3, v4 offset:8
  s_mov_b64 exec, -1
  ds_read_b64_tr_b16 v[80:81], v12 offset:43008
  ds_read_b64_tr_b16 v[82:83], v12 offset:43520
  ds_read_b64_tr_b16 v[84:85], v12 offset:43040
  ds_read_b64_tr_b16 v[86:87], v12 offset:43552
  ds_read_b64_tr_b16 v[88:89], v12 offset:43072
  ds_read_b64_tr_b16 v[90:91], v12 offset:43584
  ds_read_b64_tr_b16 v[92:93], v12 offset:43104
  ds_read_b64_tr_b16 v[94:95], v12 offset:43616
  s_waitcnt lgkmcnt(0)
  v_mfma_f32_16x16x32_bf16 v[96:99], v[80:83], v[28:31], v[96:99]
  v_mfma_f32_16x16x32_bf16 v[100:103], v[84:87], v[28:31], v[100:103]
  v_mfma_f32_16x16x32_bf16 v[104:107], v[88:91], v[28:31], v[104:107]
  v_mfma_f32_16x16x32_bf16 v[108:111], v[92:95], v[28:31], v[108:111]
  s_waitcnt lgkmcnt(0)
  s_mov_b64 exec, 1
  ds_add_u32 v3, v4 offset:52
  s_mov_b64 exec, -1
  s_mov_b32 exec_lo, 0x00ff00ff
  s_mov_b32 exec_hi, 0x00ff00ff
  s_nop 1
  v_cvt_pk_bf16_f32 v112, v96, v97
  v_cvt_pk_bf16_f32 v114, v98, v99
  v_cvt_pk_bf16_f32 v116, v104, v105
  v_cvt_pk_bf16_f32 v118, v106, v107
  s_mov_b32 exec_lo, 0xff00ff00
  s_mov_b32 exec_hi, 0xff00ff00
  v_cvt_pk_bf16_f32 v112, v100, v101
  v_cvt_pk_bf16_f32 v114, v102, v103
  v_cvt_pk_bf16_f32 v116, v108, v109
  v_cvt_pk_bf16_f32 v118, v110, v111
  s_mov_b64 exec, -1
  buffer_store_dwordx4 v[112:115], v15, s[52:55], s78 offen sc1
  buffer_store_dwordx4 v[116:119], v15, s[52:55], s78 offen offset:128 sc1
  s_mov_b64 exec, -1
  s_waitcnt vmcnt(0)
  s_waitcnt lgkmcnt(0)
  s_mov_b64 exec, 1
  ds_add_u32 v3, v4 offset:32
  s_mov_b64 exec, -1
L_Gpost:
  s_cmp_eq_u32 s3, 5
  s_cbranch_scc1 L_G1post
  s_lshl_b32 s6, s70, 8
  s_add_u32 s6, s6, 1769472
  s_getreg_b32 s7, hwreg(HW_REG_XCC_ID, 0, 4)
  s_andn2_b32 s8, s5, 15
  s_or_b32 s8, s8, s7
  v_and_b32 v19, 31, v2
  v_lshlrev_b32 v19, 3, v19
  s_mov_b32 s15, 0x400000
FW_35:
  ds_read_b32 v10, v3 offset:36
  s_waitcnt lgkmcnt(0)
  v_readfirstlane_b32 s14, v10
  s_cmp_ge_u32 s14, 4
  s_cbranch_scc1 FD_36
  s_sleep 1
  s_sub_u32 s15, s15, 1
  s_cmp_lg_u32 s15, 0
  s_cbranch_scc1 FW_35
FD_36:
  s_mov_b32 s15, 0x40000
TK_37:
  buffer_load_dwordx2 v[20:21], v19, s[52:55], s6 offen sc1
  s_waitcnt vmcnt(0)
  v_xor_b32 v22, s4, v20
  v_xor_b32 v23, s8, v21
  v_and_b32 v24, -16, v23
  v_or_b32 v24, v24, v22
  v_cmp_ne_u32 vcc, 0, v24
  s_and_b64 exec, exec, vcc
  s_cbranch_scc0 TKD_38
  s_sleep 8
  s_sub_u32 s15, s15, 1
  s_cmp_lg_u32 s15, 0
  s_cbranch_scc1 TK_37
TKD_38:
  s_mov_b64 exec, -1
  v_cmp_ne_u32 vcc, 0, v23
  s_cmp_lg_u64 vcc, 0
  s_cselect_b32 s8, 2, 1
  v_mov_b32 v20, s8
  ds_write_b32 v3, v20 offset:28
  s_waitcnt lgkmcnt(0)
  s_branch L_fin
L_G1post:
  s_mov_b32 s60, s22
  s_mov_b32 s61, s23
  s_lshl_b32 s68, s72, 10
  s_lshl_b32 s69, s70, 7
  s_add_u32 s68, s68, s69
  s_lshl_b32 s69, s73, 5
  s_add_u32 s76, s68, s69
  v_lshrrev_b32 v17, 1, v2
  v_and_b32 v16, 1, v2
  v_lshlrev_b32 v19, 4, v16
  v_mov_b32 v20, 0x3f80
  v_lshlrev_b32 v20, v19, v20
  v_bfe_u32 v19, v2, 1, 2
  v_cmp_eq_u32 vcc, 0, v19
  s_nop 1
  v_cndmask_b32 v40, 0, v20, vcc
  v_cmp_eq_u32 vcc, 1, v19
  s_nop 1
  v_cndmask_b32 v41, 0, v20, vcc
  v_cmp_eq_u32 vcc, 2, v19
  s_nop 1
  v_cndmask_b32 v42, 0, v20, vcc
  v_cmp_eq_u32 vcc, 3, v19
  s_nop 1
  v_cndmask_b32 v43, 0, v20, vcc
  v_lshlrev_b32 v21, 4, v16
  v_lshl_add_u32 v21, v6, 3, v21
  v_min_u32 v18, 27, v17
  v_lshlrev_b32 v18, 13, v18
  v_lshl_add_u32 v18, v16, 4, v18
  v_lshlrev_b32 v17, 13, v17
  v_lshl_add_u32 v17, v16, 4, v17
  s_add_u32 s77, s76, 1515520
  s_add_u32 s78, s76, 1253376
  buffer_load_dwordx2 v[44:45], v21, s[56:59], s76 offen
  v_bfe_u32 v26, v2, 2, 3
  v_lshlrev_b32 v26, 8, v26
  v_and_b32 v27, 3, v2
  v_lshl_add_u32 v26, v27, 6, v26
  s_lshl_b32 s6, s70, 3
  s_add_u32 s6, s6, 1769472
  v_mov_b32 v28, v21
  s_mov_b32 s15, 0x400000
FW_39:
  ds_read_b32 v10, v3 offset:24
  s_waitcnt lgkmcnt(0)
  v_readfirstlane_b32 s14, v10
  s_cmp_ge_u32 s14, 7
  s_cbranch_scc1 FD_40
  s_sleep 1
  s_sub_u32 s15, s15, 1
  s_cmp_lg_u32 s15, 0
  s_cbranch_scc1 FW_39
FD_40:
  s_mov_b32 s15, 0x40000
TK_41:
  buffer_load_dwordx2 v[20:21], v26, s[52:55], s6 offen sc1
  s_waitcnt vmcnt(0)
  v_xor_b32 v22, s4, v20
  v_xor_b32 v23, s5, v21
  v_and_b32 v24, -16, v23
  v_or_b32 v24, v24, v22
  v_cmp_ne_u32 vcc, 0, v24
  s_and_b64 exec, exec, vcc
  s_cbranch_scc0 TKD_42
  s_sleep 8
  s_sub_u32 s15, s15, 1
  s_cmp_lg_u32 s15, 0
  s_cbranch_scc1 TK_41
TKD_42:
  s_mov_b64 exec, -1
  v_mov_b32 v21, v28
  s_waitcnt lgkmcnt(0)
  s_barrier
  s_mov_b32 s15, 0x40000
PL_43:
  buffer_load_dwordx4 v[32:35], v18, s[52:55], s77 offen sc1
PC_45:
  s_waitcnt vmcnt(0)
  v_max3_u32 v10, v32, v33, v34
  v_max_u32 v10, v10, v35
  v_cmp_eq_u32 vcc, -1, v10
  s_and_b64 exec, exec, vcc
  s_cbranch_scc0 PD_44
  s_sleep 2
  s_sub_u32 s15, s15, 1
  s_cmp_lg_u32 s15, 0
  s_cbranch_scc1 PL_43
PD_44:
  s_mov_b64 exec, -1
  buffer_load_dwordx4 v[56:59], v17, s[52:55], s78 offen sc1
  v_cmp_gt_u32 vcc, 56, v2
  s_nop 1
  v_cndmask_b32 v32, 0, v32, vcc
  v_cndmask_b32 v33, 0, v33, vcc
  v_cndmask_b32 v34, 0, v34, vcc
  v_cndmask_b32 v35, 0, v35, vcc
  s_nop 1
  v_mfma_f32_16x16x32_bf16 v[36:39], v[40:43], v[32:35], 0
  s_nop 7
  v_add_f32_dpp v36, v36, v36 row_ror:2 row_mask:0xf bank_mask:0xf
  v_add_f32_dpp v37, v37, v37 row_ror:2 row_mask:0xf bank_mask:0xf
  v_add_f32_dpp v38, v38, v38 row_ror:2 row_mask:0xf bank_mask:0xf
  v_add_f32_dpp v39, v39, v39 row_ror:2 row_mask:0xf bank_mask:0xf
  v_add_f32_dpp v36, v36, v36 row_ror:4 row_mask:0xf bank_mask:0xf
  v_add_f32_dpp v37, v37, v37 row_ror:4 row_mask:0xf bank_mask:0xf
  v_add_f32_dpp v38, v38, v38 row_ror:4 row_mask:0xf bank_mask:0xf
  v_add_f32_dpp v39, v39, v39 row_ror:4 row_mask:0xf bank_mask:0xf
  v_add_f32_dpp v36, v36, v36 row_ror:8 row_mask:0xf bank_mask:0xf
  v_add_f32_dpp v37, v37, v37 row_ror:8 row_mask:0xf bank_mask:0xf
  v_add_f32_dpp v38, v38, v38 row_ror:8 row_mask:0xf bank_mask:0xf
  v_add_f32_dpp v39, v39, v39 row_ror:8 row_mask:0xf bank_mask:0xf
  v_cvt_pk_bf16_f32 v36, v36, v36
  v_cvt_pk_bf16_f32 v37, v37, v37
  v_cvt_pk_bf16_f32 v38, v38, v38
  v_cvt_pk_bf16_f32 v39, v39, v39
  v_and_b32 v36, 0xffff0000, v36
  v_and_b32 v37, 0xffff0000, v37
  v_and_b32 v38, 0xffff0000, v38
  v_and_b32 v39, 0xffff0000, v39
  s_mov_b32 s68, 0xbfb8aa3b
  v_mul_f32 v48, s68, v36
  v_mul_f32 v49, s68, v37
  v_mul_f32 v50, s68, v38
  v_mul_f32 v51, s68, v39
  v_exp_f32 v48, v48
  v_exp_f32 v49, v49
  v_exp_f32 v50, v50
  v_exp_f32 v51, v51
  s_nop 0
  v_add_f32 v48, 1.0, v48
  v_add_f32 v49, 1.0, v49
  v_add_f32 v50, 1.0, v50
  v_add_f32 v51, 1.0, v51
  v_rcp_f32 v48, v48
  v_rcp_f32 v49, v49
  v_rcp_f32 v50, v50
  v_rcp_f32 v51, v51
  s_nop 0
  v_mul_f32 v36, v36, v48
  v_mul_f32 v37, v37, v49
  v_mul_f32 v38, v38, v50
  v_mul_f32 v39, v39, v51
  v_cvt_pk_bf16_f32 v36, v36, v36
  v_cvt_pk_bf16_f32 v37, v37, v37
  v_cvt_pk_bf16_f32 v38, v38, v38
  v_cvt_pk_bf16_f32 v39, v39, v39
  v_and_b32 v36, 0xffff0000, v36
  v_and_b32 v37, 0xffff0000, v37
  v_and_b32 v38, 0xffff0000, v38
  v_and_b32 v39, 0xffff0000, v39
  v_mov_b32 v48, v36
  v_mov_b32 v49, v37
  v_mov_b32 v50, v38
  v_mov_b32 v51, v39
  v_lshlrev_b32 v52, 16, v44
  v_and_b32 v53, 0xffff0000, v44
  v_lshlrev_b32 v54, 16, v45
  v_and_b32 v55, 0xffff0000, v45
  s_mov_b32 s15, 0x40000
  s_branch PC_48
PL_46:
  buffer_load_dwordx4 v[56:59], v17, s[52:55], s78 offen sc1
PC_48:
  s_waitcnt vmcnt(0)
  v_max3_u32 v10, v56, v57, v58
  v_max_u32 v10, v10, v59
  v_cmp_eq_u32 vcc, -1, v10
  s_and_b64 exec, exec, vcc
  s_cbranch_scc0 PD_47
  s_sub_u32 s15, s15, 1
  s_cmp_lg_u32 s15, 0
  s_cbranch_scc1 PL_46
PD_47:
  s_mov_b64 exec, -1
  v_mfma_f32_16x16x32_bf16 v[36:39], v[40:43], v[56:59], 0
  s_nop 7
  v_add_f32_dpp v36, v36, v36 row_ror:2 row_mask:0xf bank_mask:0xf
  v_add_f32_dpp v37, v37, v37 row_ror:2 row_mask:0xf bank_mask:0xf
  v_add_f32_dpp v38, v38, v38 row_ror:2 row_mask:0xf bank_mask:0xf
  v_add_f32_dpp v39, v39, v39 row_ror:2 row_mask:0xf bank_mask:0xf
  v_add_f32_dpp v36, v36, v36 row_ror:4 row_mask:0xf bank_mask:0xf
  v_add_f32_dpp v37, v37, v37 row_ror:4 row_mask:0xf bank_mask:0xf
  v_add_f32_dpp v38, v38, v38 row_ror:4 row_mask:0xf bank_mask:0xf
  v_add_f32_dpp v39, v39, v39 row_ror:4 row_mask:0xf bank_mask:0xf
  v_add_f32_dpp v36, v36, v36 row_ror:8 row_mask:0xf bank_mask:0xf
  v_add_f32_dpp v37, v37, v37 row_ror:8 row_mask:0xf bank_mask:0xf
  v_add_f32_dpp v38, v38, v38 row_ror:8 row_mask:0xf bank_mask:0xf
  v_add_f32_dpp v39, v39, v39 row_ror:8 row_mask:0xf bank_mask:0xf
  v_cvt_pk_bf16_f32 v32, v36, v37
  v_cvt_pk_bf16_f32 v33, v38, v39
  v_lshlrev_b32 v36, 16, v32
  v_and_b32 v37, 0xffff0000, v32
  v_lshlrev_b32 v38, 16, v33
  v_and_b32 v39, 0xffff0000, v33
  v_pk_mul_f32 v[36:37], v[36:37], v[48:49]
  v_pk_mul_f32 v[38:39], v[38:39], v[50:51]
  v_cvt_pk_bf16_f32 v32, v36, v37
  v_cvt_pk_bf16_f32 v33, v38, v39
  v_lshlrev_b32 v36, 16, v32
  v_and_b32 v37, 0xffff0000, v32
  v_lshlrev_b32 v38, 16, v33
  v_and_b32 v39, 0xffff0000, v33
  v_pk_add_f32 v[36:37], v[36:37], v[52:53]
  v_pk_add_f32 v[38:39], v[38:39], v[54:55]
  v_cvt_pk_bf16_f32 v32, v36, v37
  v_cvt_pk_bf16_f32 v33, v38, v39
  s_mov_b64 exec, 0x30003
  buffer_store_dwordx2 v[32:33], v21, s[60:63], s76 offen
  s_mov_b64 exec, -1
  s_cmp_lg_u32 s2, 0
  s_cbranch_scc1 L_fin
  v_mov_b32 v32, s4
  s_mov_b32 s68, 1802240
  s_mov_b64 exec, 1
  buffer_store_dword v32, v3, s[52:55], s68 offen sc1
  s_mov_b64 exec, -1
  s_branch L_fin
L_load:
  s_setprio 2
  v_lshrrev_b32 v8, 3, v2
  v_and_b32 v9, 7, v2
  v_lshlrev_b32 v9, 4, v9
  v_lshlrev_b32 v16, 1, v6
  v_xor_b32 v16, v16, v5
  v_xor_b32 v17, 8, v16
  v_lshlrev_b32 v16, 4, v16
  v_lshl_add_u32 v16, v6, 8, v16
  v_lshlrev_b32 v17, 4, v17
  v_lshl_add_u32 v17, v6, 8, v17
  s_mov_b32 s100, s64
  s_mov_b32 s101, 63488
  v_lshl_add_u32 v18, v8, 10, v9
  v_lshlrev_b32 v21, 5, v6
  v_xor_b32 v21, v21, v18
  s_lshl_b32 s76, s74, 17
  s_lshl_b32 s68, s75, 7
  s_add_u32 s76, s76, s68
  s_mov_b32 s77, 6144
  s_lshl_b32 s78, s74, 16
  s_add_u32 s78, s78, s68
  s_mov_b32 s79, 22528
  s_waitcnt lgkmcnt(0)
  s_mov_b32 s32, s8
  s_mov_b32 s33, s9
  s_mov_b32 s44, s12
  s_mov_b32 s45, s13
  s_mov_b32 s48, s20
  s_mov_b32 s49, s21
  s_mov_b32 s52, s26
  s_mov_b32 s53, s27
  s_barrier
  s_mov_b32 s15, 0x400000
FW_49:
  ds_read_b32 v10, v3 offset:36
  s_waitcnt lgkmcnt(0)
  v_readfirstlane_b32 s14, v10
  s_cmp_ge_u32 s14, 4
  s_cbranch_scc1 FD_50
  s_sleep 1
  s_sub_u32 s15, s15, 1
  s_cmp_lg_u32 s15, 0
  s_cbranch_scc1 FW_49
FD_50:
  s_mov_b32 m0, s101
  s_add_u32 s101, s101, 1024
  buffer_load_dwordx4 v16, s[32:35], s100 offen nt lds
  s_add_u32 s100, s100, 1024
  s_mov_b32 m0, s101
  s_add_u32 s101, s101, 1024
  buffer_load_dwordx4 v16, s[32:35], s100 offen nt lds
  s_add_u32 s100, s100, 1024
  s_mov_b32 m0, s101
  s_add_u32 s101, s101, 1024
  buffer_load_dwordx4 v17, s[32:35], s100 offen nt lds
  s_add_u32 s100, s100, 1024
  s_mov_b32 m0, s101
  s_add_u32 s101, s101, 1024
  buffer_load_dwordx4 v17, s[32:35], s100 offen nt lds
  s_add_u32 s100, s100, 1024
  s_mov_b32 m0, s101
  s_add_u32 s101, s101, 1024
  buffer_load_dwordx4 v16, s[32:35], s100 offen nt lds
  s_add_u32 s100, s100, 1024
  s_mov_b32 m0, s101
  s_add_u32 s101, s101, 1024
  buffer_load_dwordx4 v16, s[32:35], s100 offen nt lds
  s_add_u32 s100, s100, 1024
  s_mov_b32 m0, s101
  s_add_u32 s101, s101, 1024
  buffer_load_dwordx4 v17, s[32:35], s100 offen nt lds
  s_add_u32 s100, s100, 1024
  s_mov_b32 m0, s101
  s_add_u32 s101, s101, 1024
  buffer_load_dwordx4 v17, s[32:35], s100 offen nt lds
  s_add_u32 s100, s100, 1024
  s_mov_b32 m0, s101
  s_add_u32 s101, s101, 1024
  buffer_load_dwordx4 v16, s[32:35], s100 offen nt lds
  s_add_u32 s100, s100, 1024
  s_mov_b32 m0, s101
  s_add_u32 s101, s101, 1024
  buffer_load_dwordx4 v16, s[32:35], s100 offen nt lds
  s_add_u32 s100, s100, 1024
  s_mov_b32 m0, s101
  s_add_u32 s101, s101, 1024
  buffer_load_dwordx4 v17, s[32:35], s100 offen nt lds
  s_add_u32 s100, s100, 1024
  s_mov_b32 m0, s101
  s_add_u32 s101, s101, 1024
  buffer_load_dwordx4 v17, s[32:35], s100 offen nt lds
  s_add_u32 s100, s100, 1024
  s_mov_b32 m0, s101
  s_add_u32 s101, s101, 1024
  buffer_load_dwordx4 v16, s[32:35], s100 offen nt lds
  s_add_u32 s100, s100, 1024
  s_mov_b32 m0, s101
  s_add_u32 s101, s101, 1024
  buffer_load_dwordx4 v16, s[32:35], s100 offen nt lds
  s_add_u32 s100, s100, 1024
  s_mov_b32 m0, s101
  s_add_u32 s101, s101, 1024
  buffer_load_dwordx4 v17, s[32:35], s100 offen nt lds
  s_add_u32 s100, s100, 1024
  s_mov_b32 m0, s101
  s_add_u32 s101, s101, 1024
  buffer_load_dwordx4 v17, s[32:35], s100 offen nt lds
  s_add_u32 s100, s100, 1024
  s_mov_b32 m0, s101
  s_add_u32 s101, s101, 1024
  buffer_load_dwordx4 v16, s[32:35], s100 offen nt lds
  s_add_u32 s100, s100, 1024
  s_mov_b32 m0, s101
  s_add_u32 s101, s101, 1024
  buffer_load_dwordx4 v16, s[32:35], s100 offen nt lds
  s_add_u32 s100, s100, 1024
  s_mov_b32 m0, s101
  s_add_u32 s101, s101, 1024
  buffer_load_dwordx4 v17, s[32:35], s100 offen nt lds
  s_add_u32 s100, s100, 1024
  s_mov_b32 m0, s101
  s_add_u32 s101, s101, 1024
  buffer_load_dwordx4 v17, s[32:35], s100 offen nt lds
  s_add_u32 s100, s100, 1024
  s_mov_b32 m0, s101
  s_add_u32 s101, s101, 1024
  buffer_load_dwordx4 v16, s[32:35], s100 offen nt lds
  s_add_u32 s100, s100, 1024
  s_mov_b32 m0, s101
  s_add_u32 s101, s101, 1024
  buffer_load_dwordx4 v16, s[32:35], s100 offen nt lds
  s_add_u32 s100, s100, 1024
  s_mov_b32 m0, s101
  s_add_u32 s101, s101, 1024
  buffer_load_dwordx4 v17, s[32:35], s100 offen nt lds
  s_add_u32 s100, s100, 1024
  s_mov_b32 m0, s101
  s_add_u32 s101, s101, 1024
  buffer_load_dwordx4 v17, s[32:35], s100 offen nt lds
  s_add_u32 s100, s100, 1024
  s_mov_b32 m0, s101
  s_add_u32 s101, s101, 1024
  buffer_load_dwordx4 v16, s[32:35], s100 offen nt lds
  s_add_u32 s100, s100, 1024
  s_mov_b32 m0, s101
  s_add_u32 s101, s101, 1024
  buffer_load_dwordx4 v16, s[32:35], s100 offen nt lds
  s_add_u32 s100, s100, 1024
  s_mov_b32 m0, s101
  s_add_u32 s101, s101, 1024
  buffer_load_dwordx4 v17, s[32:35], s100 offen nt lds
  s_add_u32 s100, s100, 1024
  s_mov_b32 m0, s101
  s_add_u32 s101, s101, 1024
  buffer_load_dwordx4 v17, s[32:35], s100 offen nt lds
  s_add_u32 s100, s100, 1024
  s_mov_b32 m0, s101
  s_add_u32 s101, s101, 1024
  buffer_load_dwordx4 v16, s[32:35], s100 offen nt lds
  s_add_u32 s100, s100, 1024
  s_mov_b32 m0, s101
  s_add_u32 s101, s101, 1024
  buffer_load_dwordx4 v16, s[32:35], s100 offen nt lds
  s_add_u32 s100, s100, 1024
  s_mov_b32 m0, s101
  s_add_u32 s101, s101, 1024
  buffer_load_dwordx4 v17, s[32:35], s100 offen nt lds
  s_add_u32 s100, s100, 1024
  s_mov_b32 m0, s101
  s_add_u32 s101, s101, 1024
  buffer_load_dwordx4 v17, s[32:35], s100 offen nt lds
  s_add_u32 s100, s100, 1024
  s_mov_b32 m0, s101
  s_add_u32 s101, s101, 1024
  buffer_load_dwordx4 v16, s[32:35], s100 offen nt lds
  s_add_u32 s100, s100, 1024
  s_mov_b32 m0, s101
  s_add_u32 s101, s101, 1024
  buffer_load_dwordx4 v16, s[32:35], s100 offen nt lds
  s_add_u32 s100, s100, 1024
  s_mov_b32 m0, s101
  s_add_u32 s101, s101, 1024
  buffer_load_dwordx4 v17, s[32:35], s100 offen nt lds
  s_add_u32 s100, s100, 1024
  s_mov_b32 m0, s101
  s_add_u32 s101, s101, 1024
  buffer_load_dwordx4 v17, s[32:35], s100 offen nt lds
  s_add_u32 s100, s100, 1024
  s_mov_b32 m0, s101
  s_add_u32 s101, s101, 1024
  buffer_load_dwordx4 v16, s[32:35], s100 offen nt lds
  s_add_u32 s100, s100, 1024
  s_mov_b32 m0, s101
  s_add_u32 s101, s101, 1024
  buffer_load_dwordx4 v16, s[32:35], s100 offen nt lds
  s_add_u32 s100, s100, 1024
  s_mov_b32 m0, s101
  s_add_u32 s101, s101, 1024
  buffer_load_dwordx4 v17, s[32:35], s100 offen nt lds
  s_add_u32 s100, s100, 1024
  s_mov_b32 m0, s101
  s_add_u32 s101, s101, 1024
  buffer_load_dwordx4 v17, s[32:35], s100 offen nt lds
  s_add_u32 s100, s100, 1024
  s_mov_b32 m0, s101
  s_add_u32 s101, s101, 1024
  buffer_load_dwordx4 v16, s[32:35], s100 offen nt lds
  s_add_u32 s100, s100, 1024
  s_mov_b32 m0, s101
  s_add_u32 s101, s101, 1024
  buffer_load_dwordx4 v16, s[32:35], s100 offen nt lds
  s_add_u32 s100, s100, 1024
  s_mov_b32 m0, s101
  s_add_u32 s101, s101, 1024
  buffer_load_dwordx4 v17, s[32:35], s100 offen nt lds
  s_add_u32 s100, s100, 1024
  s_mov_b32 m0, s101
  s_add_u32 s101, s101, 1024
  buffer_load_dwordx4 v17, s[32:35], s100 offen nt lds
  s_add_u32 s100, s100, 1024
  s_mov_b32 m0, s101
  s_add_u32 s101, s101, 1024
  buffer_load_dwordx4 v16, s[32:35], s100 offen nt lds
  s_add_u32 s100, s100, 1024
  s_mov_b32 m0, s101
  s_add_u32 s101, s101, 1024
  buffer_load_dwordx4 v16, s[32:35], s100 offen nt lds
  s_add_u32 s100, s100, 1024
  s_mov_b32 m0, s101
  s_add_u32 s101, s101, 1024
  buffer_load_dwordx4 v17, s[32:35], s100 offen nt lds
  s_add_u32 s100, s100, 1024
  s_mov_b32 m0, s101
  s_add_u32 s101, s101, 1024
  buffer_load_dwordx4 v17, s[32:35], s100 offen nt lds
  s_add_u32 s100, s100, 1024
  s_waitcnt vmcnt(47)
  s_mov_b32 m0, s101
  s_add_u32 s101, s101, 1024
  buffer_load_dwordx4 v16, s[32:35], s100 offen nt lds
  s_add_u32 s100, s100, 1024
  s_waitcnt vmcnt(47)
  s_mov_b32 m0, s101
  s_add_u32 s101, s101, 1024
  buffer_load_dwordx4 v16, s[32:35], s100 offen nt lds
  s_add_u32 s100, s100, 1024
  s_waitcnt vmcnt(47)
  s_mov_b32 m0, s101
  s_add_u32 s101, s101, 1024
  buffer_load_dwordx4 v17, s[32:35], s100 offen nt lds
  s_add_u32 s100, s100, 1024
  s_waitcnt vmcnt(47)
  s_mov_b32 m0, s101
  s_add_u32 s101, s101, 1024
  buffer_load_dwordx4 v17, s[32:35], s100 offen nt lds
  s_add_u32 s100, s100, 1024
  s_waitcnt vmcnt(47)
  s_mov_b32 m0, s101
  s_add_u32 s101, s101, 1024
  buffer_load_dwordx4 v16, s[32:35], s100 offen nt lds
  s_add_u32 s100, s100, 1024
  s_waitcnt vmcnt(47)
  s_mov_b32 m0, s101
  s_add_u32 s101, s101, 1024
  buffer_load_dwordx4 v16, s[32:35], s100 offen nt lds
  s_add_u32 s100, s100, 1024
  s_waitcnt vmcnt(47)
  s_mov_b32 m0, s101
  s_add_u32 s101, s101, 1024
  buffer_load_dwordx4 v17, s[32:35], s100 offen nt lds
  s_add_u32 s100, s100, 1024
  s_waitcnt vmcnt(47)
  v_mov_b32 v20, 1
  ds_write_b32 v3, v20 offset:24
  s_mov_b32 m0, s101
  s_add_u32 s101, s101, 1024
  buffer_load_dwordx4 v17, s[32:35], s100 offen nt lds
  s_add_u32 s100, s100, 1024
  s_waitcnt vmcnt(47)
  s_mov_b32 m0, s101
  s_add_u32 s101, s101, 1024
  buffer_load_dwordx4 v16, s[32:35], s100 offen nt lds
  s_add_u32 s100, s100, 1024
  s_waitcnt vmcnt(47)
  s_mov_b32 m0, s101
  s_add_u32 s101, s101, 1024
  buffer_load_dwordx4 v16, s[32:35], s100 offen nt lds
  s_add_u32 s100, s100, 1024
  s_waitcnt vmcnt(47)
  s_mov_b32 m0, s101
  s_add_u32 s101, s101, 1024
  buffer_load_dwordx4 v17, s[32:35], s100 offen nt lds
  s_add_u32 s100, s100, 1024
  s_waitcnt vmcnt(47)
  s_mov_b32 m0, s101
  s_add_u32 s101, s101, 1024
  buffer_load_dwordx4 v17, s[32:35], s100 offen nt lds
  s_add_u32 s100, s100, 1024
  s_waitcnt vmcnt(47)
  s_mov_b32 m0, s101
  s_add_u32 s101, s101, 1024
  buffer_load_dwordx4 v16, s[32:35], s100 offen nt lds
  s_add_u32 s100, s100, 1024
  s_waitcnt vmcnt(47)
  s_mov_b32 m0, s101
  s_add_u32 s101, s101, 1024
  buffer_load_dwordx4 v16, s[32:35], s100 offen nt lds
  s_add_u32 s100, s100, 1024
  s_waitcnt vmcnt(47)
  s_mov_b32 m0, s101
  s_add_u32 s101, s101, 1024
  buffer_load_dwordx4 v17, s[32:35], s100 offen nt lds
  s_add_u32 s100, s100, 1024
  s_waitcnt vmcnt(47)
  v_mov_b32 v20, 2
  ds_write_b32 v3, v20 offset:24
  s_mov_b32 m0, s101
  s_add_u32 s101, s101, 1024
  buffer_load_dwordx4 v17, s[32:35], s100 offen nt lds
  s_add_u32 s100, s100, 1024
  s_waitcnt vmcnt(47)
  s_mov_b32 m0, s77
  s_add_u32 s77, s77, 1024
  buffer_load_dwordx4 v21, s[44:47], s76 offen nt lds
  s_add_u32 s76, s76, 8192
  s_waitcnt vmcnt(47)
  s_mov_b32 m0, s77
  s_add_u32 s77, s77, 1024
  buffer_load_dwordx4 v21, s[44:47], s76 offen nt lds
  s_add_u32 s76, s76, 8192
  s_waitcnt vmcnt(47)
  s_mov_b32 m0, s77
  s_add_u32 s77, s77, 1024
  buffer_load_dwordx4 v21, s[44:47], s76 offen nt lds
  s_add_u32 s76, s76, 8192
  s_waitcnt vmcnt(47)
  s_mov_b32 m0, s77
  s_add_u32 s77, s77, 1024
  buffer_load_dwordx4 v21, s[44:47], s76 offen nt lds
  s_add_u32 s76, s76, 8192
  s_waitcnt vmcnt(47)
  s_mov_b32 m0, s77
  s_add_u32 s77, s77, 1024
  buffer_load_dwordx4 v21, s[44:47], s76 offen nt lds
  s_add_u32 s76, s76, 8192
  s_waitcnt vmcnt(47)
  s_mov_b32 m0, s77
  s_add_u32 s77, s77, 1024
  buffer_load_dwordx4 v21, s[44:47], s76 offen nt lds
  s_add_u32 s76, s76, 8192
  s_waitcnt vmcnt(47)
  s_mov_b32 m0, s77
  s_add_u32 s77, s77, 1024
  buffer_load_dwordx4 v21, s[44:47], s76 offen nt lds
  s_add_u32 s76, s76, 8192
  s_waitcnt vmcnt(47)
  v_mov_b32 v20, 3
  ds_write_b32 v3, v20 offset:24
  s_mov_b32 m0, s77
  s_add_u32 s77, s77, 1024
  buffer_load_dwordx4 v21, s[44:47], s76 offen nt lds
  s_add_u32 s76, s76, 8192
  s_waitcnt vmcnt(47)
  s_mov_b32 m0, s77
  s_add_u32 s77, s77, 1024
  buffer_load_dwordx4 v21, s[44:47], s76 offen nt lds
  s_add_u32 s76, s76, 8192
  s_waitcnt vmcnt(47)
  s_mov_b32 m0, s77
  s_add_u32 s77, s77, 1024
  buffer_load_dwordx4 v21, s[44:47], s76 offen nt lds
  s_add_u32 s76, s76, 8192
  s_waitcnt vmcnt(47)
  s_mov_b32 m0, s77
  s_add_u32 s77, s77, 1024
  buffer_load_dwordx4 v21, s[44:47], s76 offen nt lds
  s_add_u32 s76, s76, 8192
  s_waitcnt vmcnt(47)
  s_mov_b32 m0, s77
  s_add_u32 s77, s77, 1024
  buffer_load_dwordx4 v21, s[44:47], s76 offen nt lds
  s_add_u32 s76, s76, 8192
  s_waitcnt vmcnt(47)
  s_mov_b32 m0, s77
  s_add_u32 s77, s77, 1024
  buffer_load_dwordx4 v21, s[44:47], s76 offen nt lds
  s_add_u32 s76, s76, 8192
  s_waitcnt vmcnt(47)
  s_mov_b32 m0, s77
  s_add_u32 s77, s77, 1024
  buffer_load_dwordx4 v21, s[44:47], s76 offen nt lds
  s_add_u32 s76, s76, 8192
  s_waitcnt vmcnt(47)
  s_mov_b32 m0, s77
  s_add_u32 s77, s77, 1024
  buffer_load_dwordx4 v21, s[44:47], s76 offen nt lds
  s_add_u32 s76, s76, 8192
  s_waitcnt vmcnt(47)
  v_mov_b32 v20, 4
  ds_write_b32 v3, v20 offset:24
  s_mov_b32 m0, s77
  s_add_u32 s77, s77, 1024
  buffer_load_dwordx4 v21, s[44:47], s76 offen nt lds
  s_add_u32 s76, s76, 8192
  s_waitcnt vmcnt(40)
  v_mov_b32 v20, 5
  ds_write_b32 v3, v20 offset:24
  s_waitcnt vmcnt(32)
  v_mov_b32 v20, 6
  ds_write_b32 v3, v20 offset:24
  s_waitcnt vmcnt(24)
  v_mov_b32 v20, 7
  ds_write_b32 v3, v20 offset:24
  s_waitcnt vmcnt(16)
  v_mov_b32 v20, 8
  ds_write_b32 v3, v20 offset:24
  s_waitcnt vmcnt(0)
  ds_write_b32 v3, v4 offset:40
  s_waitcnt lgkmcnt(0)
  s_branch L_fin
L_SX1:
  s_cmp_eq_u32 s3, 7
  s_cbranch_scc1 L_X
  s_getreg_b32 s6, hwreg(HW_REG_XCC_ID, 0, 4)
  s_andn2_b32 s7, s5, 15
  s_or_b32 s7, s7, s6
  v_mov_b32 v16, s4
  v_mov_b32 v17, s7
  s_lshl_b32 s7, s70, 5
  s_add_u32 s7, s7, s71
  s_lshl_b32 s7, s7, 3
  s_add_u32 s7, s7, 1769472
  s_waitcnt vmcnt(0)
  s_mov_b64 exec, 1
  buffer_store_dwordx2 v[16:17], v3, s[52:55], s7 offen sc1
  ds_write_b32 v3, v16 offset:60
  s_mov_b64 exec, -1
  v_lshlrev_b32 v9, 11, v6
  v_lshl_add_u32 v9, v5, 4, v9
  s_lshl_b32 s16, s70, 14
  s_lshl_b32 s69, s72, 8
  s_add_u32 s16, s16, s69
  s_add_u32 s16, s16, 0
  s_add_u32 s17, s16, 8192
  s_add_u32 s18, s16, 131072
  s_add_u32 s19, s16, 139264
  s_add_u32 s20, s16, 262144
  s_add_u32 s21, s16, 270336
  s_add_u32 s22, s16, 393216
  s_add_u32 s23, s16, 401408
  v_lshlrev_b32 v8, 3, v2
  v_bfe_u32 v12, v2, 3, 2
  v_lshlrev_b32 v12, 17, v12
  v_lshl_add_u32 v12, v14, 11, v12
  s_mov_b32 s15, 0x400000
FW_51:
  ds_read_b32 v10, v3 offset:20
  s_waitcnt lgkmcnt(0)
  v_readfirstlane_b32 s14, v10
  s_cmp_ge_u32 s14, 4
  s_cbranch_scc1 FD_52
  s_sleep 1
  s_sub_u32 s15, s15, 1
  s_cmp_lg_u32 s15, 0
  s_cbranch_scc1 FW_51
FD_52:
  s_mov_b32 s15, 0x400000
FW_53:
  ds_read_b32 v10, v3 offset:32
  s_waitcnt lgkmcnt(0)
  v_readfirstlane_b32 s14, v10
  s_cmp_ge_u32 s14, 2
  s_cbranch_scc1 FD_54
  s_sleep 1
  s_sub_u32 s15, s15, 1
  s_cmp_lg_u32 s15, 0
  s_cbranch_scc1 FW_53
FD_54:
  s_mov_b32 s15, 0x3ffff
TP_55:
  buffer_load_dwordx4 v[16:19], v9, s[52:55], s16 offen sc1
  buffer_load_dwordx4 v[20:23], v9, s[52:55], s17 offen sc1
  buffer_load_dwordx4 v[24:27], v9, s[52:55], s18 offen sc1
  buffer_load_dwordx4 v[28:31], v9, s[52:55], s19 offen sc1
  buffer_load_dwordx4 v[32:35], v9, s[52:55], s20 offen sc1
  buffer_load_dwordx4 v[36:39], v9, s[52:55], s21 offen sc1
  buffer_load_dwordx4 v[40:43], v9, s[52:55], s22 offen sc1
  buffer_load_dwordx4 v[44:47], v9, s[52:55], s23 offen sc1
  s_waitcnt vmcnt(0)
  v_xor_b32 v10, s4, v17
  v_xor_b32 v11, s5, v19
  v_or_b32 v10, v10, v11
  v_xor_b32 v11, s4, v21
  v_or_b32 v10, v10, v11
  v_xor_b32 v11, s5, v23
  v_or_b32 v10, v10, v11
  v_xor_b32 v11, s4, v25
  v_or_b32 v10, v10, v11
  v_xor_b32 v11, s5, v27
  v_or_b32 v10, v10, v11
  v_xor_b32 v11, s4, v29
  v_or_b32 v10, v10, v11
  v_xor_b32 v11, s5, v31
  v_or_b32 v10, v10, v11
  v_xor_b32 v11, s4, v33
  v_or_b32 v10, v10, v11
  v_xor_b32 v11, s5, v35
  v_or_b32 v10, v10, v11
  v_xor_b32 v11, s4, v37
  v_or_b32 v10, v10, v11
  v_xor_b32 v11, s5, v39
  v_or_b32 v10, v10, v11
  v_xor_b32 v11, s4, v41
  v_or_b32 v10, v10, v11
  v_xor_b32 v11, s5, v43
  v_or_b32 v10, v10, v11
  v_xor_b32 v11, s4, v45
  v_or_b32 v10, v10, v11
  v_xor_b32 v11, s5, v47
  v_or_b32 v10, v10, v11
  v_cmp_ne_u32 vcc, 0, v10
  s_and_b64 exec, exec, vcc
  s_cbranch_scc0 TD_56
  s_sleep 2
  s_sub_u32 s15, s15, 1
  s_cmp_lg_u32 s15, 0
  s_cbranch_scc1 TP_55
TD_56:
  s_mov_b64 exec, -1
  v_lshlrev_b32 v48, 16, v16
  v_and_b32 v49, 0xffff0000, v16
  v_lshlrev_b32 v50, 16, v18
  v_and_b32 v51, 0xffff0000, v18
  v_lshlrev_b32 v52, 16, v20
  v_and_b32 v53, 0xffff0000, v20
  v_lshlrev_b32 v54, 16, v22
  v_and_b32 v55, 0xffff0000, v22
  v_lshlrev_b32 v56, 16, v24
  v_and_b32 v57, 0xffff0000, v24
  v_lshlrev_b32 v58, 16, v26
  v_and_b32 v59, 0xffff0000, v26
  v_lshlrev_b32 v60, 16, v28
  v_and_b32 v61, 0xffff0000, v28
  v_lshlrev_b32 v62, 16, v30
  v_and_b32 v63, 0xffff0000, v30
  v_lshlrev_b32 v64, 16, v32
  v_and_b32 v65, 0xffff0000, v32
  v_lshlrev_b32 v66, 16, v34
  v_and_b32 v67, 0xffff0000, v34
  v_lshlrev_b32 v68, 16, v36
  v_and_b32 v69, 0xffff0000, v36
  v_lshlrev_b32 v70, 16, v38
  v_and_b32 v71, 0xffff0000, v38
  v_lshlrev_b32 v72, 16, v40
  v_and_b32 v73, 0xffff0000, v40
  v_lshlrev_b32 v74, 16, v42
  v_and_b32 v75, 0xffff0000, v42
  v_lshlrev_b32 v76, 16, v44
  v_and_b32 v77, 0xffff0000, v44
  v_lshlrev_b32 v78, 16, v46
  v_and_b32 v79, 0xffff0000, v46
  v_add_f32 v48, v48, v56
  v_add_f32 v64, v64, v72
  v_add_f32 v49, v49, v57
  v_add_f32 v65, v65, v73
  v_add_f32 v50, v50, v58
  v_add_f32 v66, v66, v74
  v_add_f32 v51, v51, v59
  v_add_f32 v67, v67, v75
  v_add_f32 v52, v52, v60
  v_add_f32 v68, v68, v76
  v_add_f32 v53, v53, v61
  v_add_f32 v69, v69, v77
  v_add_f32 v54, v54, v62
  v_add_f32 v70, v70, v78
  v_add_f32 v55, v55, v63
  v_add_f32 v71, v71, v79
  v_add_f32 v48, v48, v64
  v_add_f32 v49, v49, v65
  v_add_f32 v50, v50, v66
  v_add_f32 v51, v51, v67
  v_add_f32 v52, v52, v68
  v_add_f32 v53, v53, v69
  v_add_f32 v54, v54, v70
  v_add_f32 v55, v55, v71
  v_cvt_pk_bf16_f32 v16, v48, v49
  v_cvt_pk_bf16_f32 v17, v50, v51
  v_cvt_pk_bf16_f32 v18, v52, v53
  v_cvt_pk_bf16_f32 v19, v54, v55
  ds_write_b64 v8, v[16:17] offset:2560
  ds_write_b64 v8, v[18:19] offset:3072
  s_waitcnt lgkmcnt(0)
  s_mov_b64 exec, 1
  ds_add_u32 v3, v4 offset:4
  s_mov_b64 exec, -1
  v_lshlrev_b32 v8, 3, v2
  v_lshlrev_b32 v9, 4, v13
  s_lshl_b32 s6, s70, 12
  s_add_u32 s6, s6, 1835008
  s_lshl_b32 s68, s71, 7
  s_add_u32 s68, s68, s6
  s_mov_b32 s78, 0x3e0293ee
  v_and_b32 v12, 31, v2
  v_lshlrev_b32 v11, 2, v12
  v_lshlrev_b32 v12, 7, v12
  s_lshr_b32 s69, s71, 3
  s_lshl_b32 s69, s69, 3
  s_add_u32 s6, s6, s69
  s_mov_b32 s15, 0x400000
FW_57:
  ds_read_b32 v10, v3 offset:16
  s_waitcnt lgkmcnt(0)
  v_readfirstlane_b32 s14, v10
  s_cmp_ge_u32 s14, 4
  s_cbranch_scc1 FD_58
  s_sleep 1
  s_sub_u32 s15, s15, 1
  s_cmp_lg_u32 s15, 0
  s_cbranch_scc1 FW_57
FD_58:
  ds_read_b128 v[16:19], v9 offset:64
  ds_read_b128 v[20:23], v9 offset:128
  s_waitcnt lgkmcnt(0)
  v_max3_f32 v24, v16, v17, v18
  v_max_f32 v24, v24, v19
  v_mul_f32 v24, s78, v24
  v_add_f32 v25, v20, v21
  v_add_f32 v26, v22, v23
  v_add_f32 v25, v25, v26
  v_min_u32 v24, -2, v24
  v_min_u32 v25, -2, v25
  s_lshl_b32 s69, s70, 10
  s_lshl_b32 s7, s71, 3
  s_add_u32 s69, s69, s7
  s_add_u32 s69, s69, 4063232
  v_lshlrev_b32 v10, 8, v2
  s_mov_b64 exec, 15
  buffer_store_dwordx2 v[24:25], v10, s[52:55], s69 offen
  buffer_store_dwordx2 v[24:25], v8, s[52:55], s68 offen sc1
  s_mov_b64 exec, -1
  s_branch L_fin
L_X:
  s_cmp_eq_u32 s70, 7
  s_cbranch_scc1 L_fin
  s_mov_b32 s6, s74
  s_mov_b32 s7, s75
  v_lshl_add_u32 v12, v13, 4, v12
  v_lshl_add_u32 v10, v8, 10, v9
  s_lshl_b32 s100, s6, 16
  s_lshl_b32 s69, s7, 7
  s_add_u32 s100, s100, s69
  v_mov_b32 v11, v7
  s_lshl_b32 s76, s6, 11
  s_add_u32 s76, s76, 524288
  v_lshlrev_b32 v15, 10, v14
  v_lshl_add_u32 v15, v6, 4, v15
  v_bfe_u32 v9, v2, 3, 1
  v_lshl_add_u32 v15, v9, 6, v15
  s_lshl_b32 s78, s6, 13
  s_add_u32 s78, s78, s69
  s_add_u32 s78, s78, 1515520
  s_add_u32 s16, s76, 0
  s_add_u32 s17, s76, 57344
  s_add_u32 s18, s76, 114688
  s_add_u32 s19, s76, 172032
  s_add_u32 s20, s76, 229376
  s_add_u32 s21, s76, 286720
  s_add_u32 s22, s76, 344064
  s_add_u32 s23, s76, 401408
  s_mov_b32 s15, 0x400000
FW_59:
  ds_read_b32 v9, v3 offset:20
  s_waitcnt lgkmcnt(0)
  v_readfirstlane_b32 s14, v9
  s_cmp_ge_u32 s14, 4
  s_cbranch_scc1 FD_60
  s_sleep 1
  s_sub_u32 s15, s15, 1
  s_cmp_lg_u32 s15, 0
  s_cbranch_scc1 FW_59
FD_60:
  s_mov_b32 s15, 0x400000
FW_61:
  ds_read_b32 v9, v3 offset:32
  s_waitcnt lgkmcnt(0)
  v_readfirstlane_b32 s14, v9
  s_cmp_ge_u32 s14, 2
  s_cbranch_scc1 FD_62
  s_sleep 1
  s_sub_u32 s15, s15, 1
  s_cmp_lg_u32 s15, 0
  s_cbranch_scc1 FW_61
FD_62:
  s_mov_b32 s68, 22528
  s_mov_b32 s69, 51200
  s_add_u32 s101, s100, 128
  s_mov_b32 m0, s68
  s_add_u32 s68, s68, 1024
  buffer_load_dwordx4 v10, s[48:51], s100 offen nt lds
  s_add_u32 s100, s100, 8192
  s_mov_b32 m0, s68
  s_add_u32 s68, s68, 1024
  buffer_load_dwordx4 v10, s[48:51], s100 offen nt lds
  s_add_u32 s100, s100, 8192
  s_mov_b32 m0, s68
  s_add_u32 s68, s68, 1024
  buffer_load_dwordx4 v10, s[48:51], s100 offen nt lds
  s_add_u32 s100, s100, 8192
  s_mov_b32 m0, s68
  s_add_u32 s68, s68, 1024
  buffer_load_dwordx4 v10, s[48:51], s100 offen nt lds
  s_add_u32 s100, s100, 8192
  s_mov_b32 m0, s68
  s_add_u32 s68, s68, 1024
  buffer_load_dwordx4 v10, s[48:51], s100 offen nt lds
  s_add_u32 s100, s100, 8192
  s_mov_b32 m0, s68
  s_add_u32 s68, s68, 1024
  buffer_load_dwordx4 v10, s[48:51], s100 offen nt lds
  s_add_u32 s100, s100, 8192
  s_mov_b32 m0, s68
  s_add_u32 s68, s68, 1024
  buffer_load_dwordx4 v10, s[48:51], s100 offen nt lds
  s_add_u32 s100, s100, 8192
  s_mov_b32 m0, s68
  s_add_u32 s68, s68, 1024
  buffer_load_dwordx4 v10, s[48:51], s100 offen nt lds
  s_add_u32 s100, s100, 8192
  s_mov_b32 s15, 0x3ffff
TP_63:
  buffer_load_dwordx4 v[16:19], v11, s[52:55], s16 offen sc1
  buffer_load_dwordx4 v[20:23], v11, s[52:55], s16 offen offset:1024 sc1
  buffer_load_dwordx4 v[24:27], v11, s[52:55], s17 offen sc1
  buffer_load_dwordx4 v[28:31], v11, s[52:55], s17 offen offset:1024 sc1
  buffer_load_dwordx4 v[32:35], v11, s[52:55], s18 offen sc1
  buffer_load_dwordx4 v[36:39], v11, s[52:55], s18 offen offset:1024 sc1
  buffer_load_dwordx4 v[40:43], v11, s[52:55], s19 offen sc1
  buffer_load_dwordx4 v[44:47], v11, s[52:55], s19 offen offset:1024 sc1
  buffer_load_dwordx4 v[48:51], v11, s[52:55], s20 offen sc1
  buffer_load_dwordx4 v[52:55], v11, s[52:55], s20 offen offset:1024 sc1
  buffer_load_dwordx4 v[56:59], v11, s[52:55], s21 offen sc1
  buffer_load_dwordx4 v[60:63], v11, s[52:55], s21 offen offset:1024 sc1
  buffer_load_dwordx4 v[64:67], v11, s[52:55], s22 offen sc1
  buffer_load_dwordx4 v[68:71], v11, s[52:55], s22 offen offset:1024 sc1
  buffer_load_dwordx4 v[72:75], v11, s[52:55], s23 offen sc1
  buffer_load_dwordx4 v[76:79], v11, s[52:55], s23 offen offset:1024 sc1
  s_waitcnt vmcnt(0)
  v_xor_b32 v8, s4, v17
  v_xor_b32 v9, s5, v19
  v_or_b32 v8, v8, v9
  v_xor_b32 v9, s4, v21
  v_or_b32 v8, v8, v9
  v_xor_b32 v9, s5, v23
  v_or_b32 v8, v8, v9
  v_xor_b32 v9, s4, v25
  v_or_b32 v8, v8, v9
  v_xor_b32 v9, s5, v27
  v_or_b32 v8, v8, v9
  v_xor_b32 v9, s4, v29
  v_or_b32 v8, v8, v9
  v_xor_b32 v9, s5, v31
  v_or_b32 v8, v8, v9
  v_xor_b32 v9, s4, v33
  v_or_b32 v8, v8, v9
  v_xor_b32 v9, s5, v35
  v_or_b32 v8, v8, v9
  v_xor_b32 v9, s4, v37
  v_or_b32 v8, v8, v9
  v_xor_b32 v9, s5, v39
  v_or_b32 v8, v8, v9
  v_xor_b32 v9, s4, v41
  v_or_b32 v8, v8, v9
  v_xor_b32 v9, s5, v43
  v_or_b32 v8, v8, v9
  v_xor_b32 v9, s4, v45
  v_or_b32 v8, v8, v9
  v_xor_b32 v9, s5, v47
  v_or_b32 v8, v8, v9
  v_xor_b32 v9, s4, v49
  v_or_b32 v8, v8, v9
  v_xor_b32 v9, s5, v51
  v_or_b32 v8, v8, v9
  v_xor_b32 v9, s4, v53
  v_or_b32 v8, v8, v9
  v_xor_b32 v9, s5, v55
  v_or_b32 v8, v8, v9
  v_xor_b32 v9, s4, v57
  v_or_b32 v8, v8, v9
  v_xor_b32 v9, s5, v59
  v_or_b32 v8, v8, v9
  v_xor_b32 v9, s4, v61
  v_or_b32 v8, v8, v9
  v_xor_b32 v9, s5, v63
  v_or_b32 v8, v8, v9
  v_xor_b32 v9, s4, v65
  v_or_b32 v8, v8, v9
  v_xor_b32 v9, s5, v67
  v_or_b32 v8, v8, v9
  v_xor_b32 v9, s4, v69
  v_or_b32 v8, v8, v9
  v_xor_b32 v9, s5, v71
  v_or_b32 v8, v8, v9
  v_xor_b32 v9, s4, v73
  v_or_b32 v8, v8, v9
  v_xor_b32 v9, s5, v75
  v_or_b32 v8, v8, v9
  v_xor_b32 v9, s4, v77
  v_or_b32 v8, v8, v9
  v_xor_b32 v9, s5, v79
  v_or_b32 v8, v8, v9
  v_cmp_ne_u32 vcc, 0, v8
  s_and_b64 exec, exec, vcc
  s_cbranch_scc0 TD_64
  s_sleep 2
  s_sub_u32 s15, s15, 1
  s_cmp_lg_u32 s15, 0
  s_cbranch_scc1 TP_63
TD_64:
  s_mov_b64 exec, -1
  v_lshlrev_b32 v80, 16, v16
  v_and_b32 v81, 0xffff0000, v16
  v_lshlrev_b32 v82, 16, v18
  v_and_b32 v83, 0xffff0000, v18
  v_lshlrev_b32 v84, 16, v20
  v_and_b32 v85, 0xffff0000, v20
  v_lshlrev_b32 v86, 16, v22
  v_and_b32 v87, 0xffff0000, v22
  v_lshlrev_b32 v88, 16, v24
  v_and_b32 v89, 0xffff0000, v24
  v_lshlrev_b32 v90, 16, v26
  v_and_b32 v91, 0xffff0000, v26
  v_lshlrev_b32 v92, 16, v28
  v_and_b32 v93, 0xffff0000, v28
  v_lshlrev_b32 v94, 16, v30
  v_and_b32 v95, 0xffff0000, v30
  v_lshlrev_b32 v96, 16, v32
  v_and_b32 v97, 0xffff0000, v32
  v_lshlrev_b32 v98, 16, v34
  v_and_b32 v99, 0xffff0000, v34
  v_lshlrev_b32 v100, 16, v36
  v_and_b32 v101, 0xffff0000, v36
  v_lshlrev_b32 v102, 16, v38
  v_and_b32 v103, 0xffff0000, v38
  v_lshlrev_b32 v104, 16, v40
  v_and_b32 v105, 0xffff0000, v40
  v_lshlrev_b32 v106, 16, v42
  v_and_b32 v107, 0xffff0000, v42
  v_lshlrev_b32 v108, 16, v44
  v_and_b32 v109, 0xffff0000, v44
  v_lshlrev_b32 v110, 16, v46
  v_and_b32 v111, 0xffff0000, v46
  v_lshlrev_b32 v112, 16, v48
  v_and_b32 v113, 0xffff0000, v48
  v_lshlrev_b32 v114, 16, v50
  v_and_b32 v115, 0xffff0000, v50
  v_lshlrev_b32 v116, 16, v52
  v_and_b32 v117, 0xffff0000, v52
  v_lshlrev_b32 v118, 16, v54
  v_and_b32 v119, 0xffff0000, v54
  v_lshlrev_b32 v120, 16, v56
  v_and_b32 v121, 0xffff0000, v56
  v_lshlrev_b32 v122, 16, v58
  v_and_b32 v123, 0xffff0000, v58
  v_lshlrev_b32 v124, 16, v60
  v_and_b32 v125, 0xffff0000, v60
  v_lshlrev_b32 v126, 16, v62
  v_and_b32 v127, 0xffff0000, v62
  v_lshlrev_b32 v128, 16, v64
  v_and_b32 v129, 0xffff0000, v64
  v_lshlrev_b32 v130, 16, v66
  v_and_b32 v131, 0xffff0000, v66
  v_lshlrev_b32 v132, 16, v68
  v_and_b32 v133, 0xffff0000, v68
  v_lshlrev_b32 v134, 16, v70
  v_and_b32 v135, 0xffff0000, v70
  v_lshlrev_b32 v136, 16, v72
  v_and_b32 v137, 0xffff0000, v72
  v_lshlrev_b32 v138, 16, v74
  v_and_b32 v139, 0xffff0000, v74
  v_lshlrev_b32 v140, 16, v76
  v_and_b32 v141, 0xffff0000, v76
  v_lshlrev_b32 v142, 16, v78
  v_and_b32 v143, 0xffff0000, v78
  v_add_f32 v80, v80, v88
  v_add_f32 v96, v96, v104
  v_add_f32 v81, v81, v89
  v_add_f32 v97, v97, v105
  v_add_f32 v82, v82, v90
  v_add_f32 v98, v98, v106
  v_add_f32 v83, v83, v91
  v_add_f32 v99, v99, v107
  v_add_f32 v84, v84, v92
  v_add_f32 v100, v100, v108
  v_add_f32 v85, v85, v93
  v_add_f32 v101, v101, v109
  v_add_f32 v86, v86, v94
  v_add_f32 v102, v102, v110
  v_add_f32 v87, v87, v95
  v_add_f32 v103, v103, v111
  v_add_f32 v80, v80, v96
  v_add_f32 v81, v81, v97
  v_add_f32 v82, v82, v98
  v_add_f32 v83, v83, v99
  v_add_f32 v84, v84, v100
  v_add_f32 v85, v85, v101
  v_add_f32 v86, v86, v102
  v_add_f32 v87, v87, v103
  v_add_f32 v112, v112, v120
  v_add_f32 v128, v128, v136
  v_add_f32 v113, v113, v121
  v_add_f32 v129, v129, v137
  v_add_f32 v114, v114, v122
  v_add_f32 v130, v130, v138
  v_add_f32 v115, v115, v123
  v_add_f32 v131, v131, v139
  v_add_f32 v116, v116, v124
  v_add_f32 v132, v132, v140
  v_add_f32 v117, v117, v125
  v_add_f32 v133, v133, v141
  v_add_f32 v118, v118, v126
  v_add_f32 v134, v134, v142
  v_add_f32 v119, v119, v127
  v_add_f32 v135, v135, v143
  v_add_f32 v112, v112, v128
  v_add_f32 v113, v113, v129
  v_add_f32 v114, v114, v130
  v_add_f32 v115, v115, v131
  v_add_f32 v116, v116, v132
  v_add_f32 v117, v117, v133
  v_add_f32 v118, v118, v134
  v_add_f32 v119, v119, v135
  v_cvt_pk_bf16_f32 v80, v80, v80
  v_cvt_pk_bf16_f32 v81, v81, v81
  v_cvt_pk_bf16_f32 v82, v82, v82
  v_cvt_pk_bf16_f32 v83, v83, v83
  v_cvt_pk_bf16_f32 v84, v84, v84
  v_cvt_pk_bf16_f32 v85, v85, v85
  v_cvt_pk_bf16_f32 v86, v86, v86
  v_cvt_pk_bf16_f32 v87, v87, v87
  v_cvt_pk_bf16_f32 v112, v112, v112
  v_cvt_pk_bf16_f32 v113, v113, v113
  v_cvt_pk_bf16_f32 v114, v114, v114
  v_cvt_pk_bf16_f32 v115, v115, v115
  v_cvt_pk_bf16_f32 v116, v116, v116
  v_cvt_pk_bf16_f32 v117, v117, v117
  v_cvt_pk_bf16_f32 v118, v118, v118
  v_cvt_pk_bf16_f32 v119, v119, v119
  v_and_b32 v80, 0xffff0000, v80
  v_and_b32 v81, 0xffff0000, v81
  v_and_b32 v82, 0xffff0000, v82
  v_and_b32 v83, 0xffff0000, v83
  v_and_b32 v84, 0xffff0000, v84
  v_and_b32 v85, 0xffff0000, v85
  v_and_b32 v86, 0xffff0000, v86
  v_and_b32 v87, 0xffff0000, v87
  v_and_b32 v112, 0xffff0000, v112
  v_and_b32 v113, 0xffff0000, v113
  v_and_b32 v114, 0xffff0000, v114
  v_and_b32 v115, 0xffff0000, v115
  v_and_b32 v116, 0xffff0000, v116
  v_and_b32 v117, 0xffff0000, v117
  v_and_b32 v118, 0xffff0000, v118
  v_and_b32 v119, 0xffff0000, v119
  s_mov_b32 s68, 0xbfb8aa3b
  v_mul_f32 v88, s68, v80
  v_mul_f32 v89, s68, v81
  v_mul_f32 v90, s68, v82
  v_mul_f32 v91, s68, v83
  v_mul_f32 v92, s68, v84
  v_mul_f32 v93, s68, v85
  v_mul_f32 v94, s68, v86
  v_mul_f32 v95, s68, v87
  v_exp_f32 v88, v88
  v_exp_f32 v89, v89
  v_exp_f32 v90, v90
  v_exp_f32 v91, v91
  v_exp_f32 v92, v92
  v_exp_f32 v93, v93
  v_exp_f32 v94, v94
  v_exp_f32 v95, v95
  s_nop 0
  v_add_f32 v88, 1.0, v88
  v_add_f32 v89, 1.0, v89
  v_add_f32 v90, 1.0, v90
  v_add_f32 v91, 1.0, v91
  v_add_f32 v92, 1.0, v92
  v_add_f32 v93, 1.0, v93
  v_add_f32 v94, 1.0, v94
  v_add_f32 v95, 1.0, v95
  v_rcp_f32 v88, v88
  v_rcp_f32 v89, v89
  v_rcp_f32 v90, v90
  v_rcp_f32 v91, v91
  v_rcp_f32 v92, v92
  v_rcp_f32 v93, v93
  v_rcp_f32 v94, v94
  v_rcp_f32 v95, v95
  s_nop 0
  v_mul_f32 v80, v80, v88
  v_mul_f32 v81, v81, v89
  v_mul_f32 v82, v82, v90
  v_mul_f32 v83, v83, v91
  v_mul_f32 v84, v84, v92
  v_mul_f32 v85, v85, v93
  v_mul_f32 v86, v86, v94
  v_mul_f32 v87, v87, v95
  v_cvt_pk_bf16_f32 v80, v80, v80
  v_cvt_pk_bf16_f32 v81, v81, v81
  v_cvt_pk_bf16_f32 v82, v82, v82
  v_cvt_pk_bf16_f32 v83, v83, v83
  v_cvt_pk_bf16_f32 v84, v84, v84
  v_cvt_pk_bf16_f32 v85, v85, v85
  v_cvt_pk_bf16_f32 v86, v86, v86
  v_cvt_pk_bf16_f32 v87, v87, v87
  v_and_b32 v80, 0xffff0000, v80
  v_and_b32 v81, 0xffff0000, v81
  v_and_b32 v82, 0xffff0000, v82
  v_and_b32 v83, 0xffff0000, v83
  v_and_b32 v84, 0xffff0000, v84
  v_and_b32 v85, 0xffff0000, v85
  v_and_b32 v86, 0xffff0000, v86
  v_and_b32 v87, 0xffff0000, v87
  v_mul_f32 v80, v80, v112
  v_mul_f32 v81, v81, v113
  v_mul_f32 v82, v82, v114
  v_mul_f32 v83, v83, v115
  v_mul_f32 v84, v84, v116
  v_mul_f32 v85, v85, v117
  v_mul_f32 v86, v86, v118
  v_mul_f32 v87, v87, v119
  v_cvt_pk_bf16_f32 v16, v80, v81
  v_cvt_pk_bf16_f32 v17, v82, v83
  v_cvt_pk_bf16_f32 v18, v84, v85
  v_cvt_pk_bf16_f32 v19, v86, v87
  s_mov_b32 s15, 0x400000
FW_65:
  ds_read_b32 v9, v3 offset:4
  s_waitcnt lgkmcnt(0)
  v_readfirstlane_b32 s14, v9
  s_cmp_ge_u32 s14, 1
  s_cbranch_scc1 FD_66
  s_sleep 1
  s_sub_u32 s15, s15, 1
  s_cmp_lg_u32 s15, 0
  s_cbranch_scc1 FW_65
FD_66:
  ds_read_b64_tr_b16 v[128:129], v12 offset:22528
  ds_read_b64_tr_b16 v[130:131], v12 offset:23040
  ds_read_b64_tr_b16 v[132:133], v12 offset:22536
  ds_read_b64_tr_b16 v[134:135], v12 offset:23048
  ds_read_b64_tr_b16 v[136:137], v12 offset:22592
  ds_read_b64_tr_b16 v[138:139], v12 offset:23104
  ds_read_b64_tr_b16 v[140:141], v12 offset:22600
  ds_read_b64_tr_b16 v[142:143], v12 offset:23112
  ds_read_b64_tr_b16 v[144:145], v12 offset:26624
  ds_read_b64_tr_b16 v[146:147], v12 offset:27136
  ds_read_b64_tr_b16 v[148:149], v12 offset:26632
  ds_read_b64_tr_b16 v[150:151], v12 offset:27144
  ds_read_b64_tr_b16 v[152:153], v12 offset:26688
  ds_read_b64_tr_b16 v[154:155], v12 offset:27200
  ds_read_b64_tr_b16 v[156:157], v12 offset:26696
  ds_read_b64_tr_b16 v[158:159], v12 offset:27208
  s_waitcnt lgkmcnt(0)
  v_mfma_f32_16x16x32_bf16 v[32:35], v[128:131], v[16:19], 0
  v_mfma_f32_16x16x32_bf16 v[36:39], v[132:135], v[16:19], 0
  v_mfma_f32_16x16x32_bf16 v[40:43], v[136:139], v[16:19], 0
  v_mfma_f32_16x16x32_bf16 v[44:47], v[140:143], v[16:19], 0
  v_mfma_f32_16x16x32_bf16 v[48:51], v[144:147], v[16:19], 0
  v_mfma_f32_16x16x32_bf16 v[52:55], v[148:151], v[16:19], 0
  v_mfma_f32_16x16x32_bf16 v[56:59], v[152:155], v[16:19], 0
  v_mfma_f32_16x16x32_bf16 v[60:63], v[156:159], v[16:19], 0
  s_nop 7
  v_add_f32_dpp v64, v48, v32 row_ror:8 row_mask:0xf bank_mask:0x3
  v_add_f32_dpp v64, v40, v56 row_ror:8 row_mask:0xf bank_mask:0xc
  v_add_f32_dpp v65, v49, v33 row_ror:8 row_mask:0xf bank_mask:0x3
  v_add_f32_dpp v65, v41, v57 row_ror:8 row_mask:0xf bank_mask:0xc
  v_add_f32_dpp v66, v50, v34 row_ror:8 row_mask:0xf bank_mask:0x3
  v_add_f32_dpp v66, v42, v58 row_ror:8 row_mask:0xf bank_mask:0xc
  v_add_f32_dpp v67, v51, v35 row_ror:8 row_mask:0xf bank_mask:0x3
  v_add_f32_dpp v67, v43, v59 row_ror:8 row_mask:0xf bank_mask:0xc
  v_add_f32_dpp v68, v52, v36 row_ror:8 row_mask:0xf bank_mask:0x3
  v_add_f32_dpp v68, v44, v60 row_ror:8 row_mask:0xf bank_mask:0xc
  v_add_f32_dpp v69, v53, v37 row_ror:8 row_mask:0xf bank_mask:0x3
  v_add_f32_dpp v69, v45, v61 row_ror:8 row_mask:0xf bank_mask:0xc
  v_add_f32_dpp v70, v54, v38 row_ror:8 row_mask:0xf bank_mask:0x3
  v_add_f32_dpp v70, v46, v62 row_ror:8 row_mask:0xf bank_mask:0xc
  v_add_f32_dpp v71, v55, v39 row_ror:8 row_mask:0xf bank_mask:0x3
  v_add_f32_dpp v71, v47, v63 row_ror:8 row_mask:0xf bank_mask:0xc
  v_cvt_pk_bf16_f32 v72, v64, v65
  v_cvt_pk_bf16_f32 v73, v66, v67
  v_cvt_pk_bf16_f32 v74, v68, v69
  v_cvt_pk_bf16_f32 v75, v70, v71
  v_min_u32 v72, -2, v72
  v_min_u32 v73, -2, v73
  v_min_u32 v74, -2, v74
  v_min_u32 v75, -2, v75
  buffer_store_dwordx4 v[72:75], v15, s[52:55], s78 offen sc1
L_fin:
L_end:
  s_endpgm
.section .rodata,"a"
.p2align 6
.amdhsa_kernel recurrent_scan__sliding_block_cached__swiglu_ffn__decode_kernel
  .amdhsa_next_free_vgpr 168
  .amdhsa_next_free_sgpr 102
  .amdhsa_accum_offset 168
  .amdhsa_group_segment_fixed_size 0
  .amdhsa_kernarg_size 96
  .amdhsa_user_sgpr_count 2
  .amdhsa_user_sgpr_kernarg_segment_ptr 1
  .amdhsa_system_sgpr_workgroup_id_x 1
  .amdhsa_float_denorm_mode_32 3
.end_amdhsa_kernel
```
